```python
import torch

def _softmax(x, axis=-1):
    return torch.softmax(x, dim=axis)
def _gelu(x):
    return torch.nn.functional.gelu(x, approximate="tanh")
def _silu(x):
    return torch.nn.functional.silu(x)
def _sigmoid(x):
    return torch.sigmoid(x)
def _layernorm(x, axis=-1, eps=1e-5):
    m = x.mean(dim=axis, keepdim=True)
    v = x.var(dim=axis, keepdim=True, unbiased=False)
    return (x - m) / torch.sqrt(v + eps)
def _scatter_add(tgt, idx, src, axis=0):
    return tgt.clone().index_add_(axis, idx, src)
def _segment_sum(src, seg, n):
    out = torch.zeros((n,) + src.shape[1:], dtype=src.dtype)
    return out.index_add_(0, seg, src)
def _pad(x, pw):
    flat = tuple(v for pair in reversed(pw) for v in pair)
    return torch.nn.functional.pad(x, flat)

kernel_name = 'sequential_preLN__sliding_block_cached__moe_arch_mod__decode'

def setup_inputs():

    _w = (lambda a: (lambda t: t.to(torch.bfloat16) if t.is_floating_point() else t)(torch.as_tensor(a)))
    def _A_setup():
        B, Sq, D = 2, 1, 512
        Hq, Hkv, Sk, Dh = 32, 32, 16384, 128
        assert Hq % Hkv == 0, (Hq, Hkv)
        return {
            "x": _w((lambda *s: torch.randn(*s, dtype=torch.bfloat16) * 0.05)(B, Sq, D)),
            "k_cache": _w((lambda *s: torch.randn(*s, dtype=torch.bfloat16) * 3.2)(B, Hkv, Sk, Dh)),
            "v_cache": _w((lambda *s: torch.randn(*s, dtype=torch.bfloat16) * 0.4)(B, Hkv, Sk, Dh)),
            "wq": _w((lambda *s: torch.randn(*s, dtype=torch.bfloat16) * 3.2)(D, Hq * Dh) * (D ** -0.5)),
            "wo": _w((lambda *s: torch.randn(*s, dtype=torch.bfloat16) * 0.4)(Hq * Dh, D) * ((Hq * Dh) ** -0.5)),
        }
    _A_in = _A_setup()

    def _B_setup():
        B, S, D, F, C = 2, 1, 512, 1376, 1
        return {
            "x": _w((lambda *s: torch.randn(*s, dtype=torch.bfloat16) * 0.05)(B, S, D)),
            "w_r": _w((lambda *s: torch.randn(*s, dtype=torch.bfloat16) * 3.2)(D)),
            "w_gate": _w((lambda *s: torch.randn(*s, dtype=torch.bfloat16) * 0.1)(D, F)),
            "w_up": _w((lambda *s: torch.randn(*s, dtype=torch.bfloat16) * 0.1)(D, F)),
            "w_down": _w((lambda *s: torch.randn(*s, dtype=torch.bfloat16) * 0.1)(F, D)),
        }
    _B_in = _B_setup()

    return {
        "A_x": _A_in["x"],
        "A_k_cache": _A_in["k_cache"],
        "A_v_cache": _A_in["v_cache"],
        "A_wq": _A_in["wq"],
        "A_wo": _A_in["wo"],
        "B_x": _B_in["x"],
        "B_w_r": _B_in["w_r"],
        "B_w_gate": _B_in["w_gate"],
        "B_w_up": _B_in["w_up"],
        "B_w_down": _B_in["w_down"],
    }

def reference(A_x, A_k_cache, A_v_cache, A_wq, A_wo, B_x, B_w_r, B_w_gate, B_w_up, B_w_down):
    def _A_ref(x, k_cache, v_cache, wq, wo):
        B, Sq, D = x.shape
        Hq, Dh = 32, 128
        Hkv, Sk = k_cache.shape[1], k_cache.shape[2]
        W = min(4096, max(256, Sk // 4))
        rep = Hq // Hkv
        q = (lambda x, *d: x.permute(*d))((x @ wq).reshape(B, Sq, Hq, Dh), 0, 2, 1, 3)
        k = (lambda x, n, axis: torch.repeat_interleave(x, n, dim=axis))(k_cache[:, :, Sk - W:, :], rep, axis=1)
        v = (lambda x, n, axis: torch.repeat_interleave(x, n, dim=axis))(v_cache[:, :, Sk - W:, :], rep, axis=1)
        scores = torch.einsum("bhqd,bhkd->bhqk", q, k) * (Dh ** -0.5)
        p = _softmax(scores, axis=-1)
        o = torch.einsum("bhqk,bhkd->bhqd", p, v)
        return (lambda x, *d: x.permute(*d))(o, 0, 2, 1, 3).reshape(B, Sq, Hq * Dh) @ wo

    def _B_ref(x, w_r, w_gate, w_up, w_down):
        B, S, D = x.shape
        C = 1
        r = x @ w_r
        idx = torch.argsort(-r, axis=-1)[:, :C]
        idx_e = (lambda x, n, axis: torch.repeat_interleave(x, n, dim=axis))(idx.reshape(B, C, 1), D, axis=2)
        x_sel = (lambda x, i, axis: torch.take_along_dim(x, i, dim=axis))(x, idx_e, axis=1)
        g = _silu(x_sel @ w_gate)
        u = x_sel @ w_up
        y = (g * u) @ w_down
        r_sel = _sigmoid((lambda x, i, axis: torch.take_along_dim(x, i, dim=axis))(r, idx, axis=1))
        y = y * r_sel.reshape(B, C, 1)
        b_off = (torch.arange(B) * S).reshape(B, 1)
        flat_idx = (idx + b_off).reshape(B * C)
        zero = (x * 0.0).reshape(B * S, D)
        upd = _scatter_add(zero, flat_idx, y.reshape(B * C, D), axis=0)
        return x + upd.reshape(B, S, D)

    x = A_x
    h = x + _A_ref(_layernorm(x, axis=-1), A_k_cache, A_v_cache, A_wq, A_wo)
    h2 = h + _B_ref(_layernorm(h, axis=-1), B_w_r, B_w_gate, B_w_up, B_w_down)
    return h2
```

```asm
; @launch grid=(256,1,1) block=(768,1,1) lds=110592
.amdgcn_target "amdgcn-amd-amdhsa--gfx950"
.text
.globl sequential_preLN__sliding_block_cached__moe_arch_mod__decode_kernel
.p2align 8
.type sequential_preLN__sliding_block_cached__moe_arch_mod__decode_kernel,@function
sequential_preLN__sliding_block_cached__moe_arch_mod__decode_kernel:
  s_load_dwordx2 s[12:13], s[0:1], 8
  s_load_dwordx2 s[4:5], s[0:1], 0
  s_load_dwordx2 s[8:9], s[0:1], 24
  s_load_dwordx2 s[24:25], s[0:1], 96
  s_cmp_ge_u32 s2, 256
  s_cbranch_scc1 L_end
  v_lshrrev_b32 v2, 6, v0
  v_and_b32 v0, 63, v0
  v_readfirstlane_b32 s3, v2
  v_lshlrev_b32 v1, 4, v0
  s_mov_b32 s14, 0x10000000
  s_mov_b32 s15, 0x20000
  s_movk_i32 s6, 2048
  s_mov_b32 s7, 0x20000
  s_mov_b32 s26, 1032192
  s_mov_b32 s27, 0x20000
  s_lshr_b32 s57, s2, 6
  s_cmp_ge_u32 s3, 8
  s_cbranch_scc1 L_aux
  s_and_b32 s52, s2, 63
  s_lshl_b32 s52, s52, 2
  s_add_u32 s52, s52, 3
  s_lshl_b32 s52, s52, 20
  s_lshl_b32 s53, s3, 12
  s_xor_b32 s52, s52, s53
  s_bfe_u32 s53, s2, 0x20003
  s_lshl_b32 s53, s53, 10
  s_xor_b32 s52, s52, s53
  s_bfe_u32 s53, s2, 0x10005
  s_lshl_b32 s53, s53, 15
  s_xor_b32 s52, s52, s53
  s_lshl_b32 s53, s57, 18
  s_xor_b32 s52, s52, s53
  s_lshl_b32 s53, s57, 16
  s_xor_b32 s52, s52, s53
  s_waitcnt lgkmcnt(0)
  buffer_load_dwordx4 v[44:47], v1, s[12:15], s52 offen nt
  s_xor_b32 s53, s52, 1024
  buffer_load_dwordx4 v[48:51], v1, s[12:15], s53 offen nt
  s_load_dwordx2 s[16:17], s[0:1], 16
  s_mov_b32 s18, 268435456
  s_mov_b32 s19, 0x20000
  s_load_dword s28, s[24:25], 0
  s_mov_b32 s64, 0xcccccccc
  s_mov_b32 s65, 0xcccccccc
  s_mov_b32 s66, 0xaaaaaaaa
  s_mov_b32 s67, 0xaaaaaaaa
  v_and_b32 v12, 1, v0
  v_lshlrev_b32 v12, 4, v12
  v_mov_b32 v13, 0xffff
  v_lshlrev_b32 v12, v12, v13
  v_bfe_u32 v13, v0, 1, 3
  v_cmp_eq_u32 vcc, 0, v13
  s_nop 1
  v_cndmask_b32 v4, 0, v12, vcc
  v_cmp_eq_u32 vcc, 1, v13
  s_nop 1
  v_cndmask_b32 v5, 0, v12, vcc
  v_cmp_eq_u32 vcc, 2, v13
  s_nop 1
  v_cndmask_b32 v6, 0, v12, vcc
  v_cmp_eq_u32 vcc, 3, v13
  s_nop 1
  v_cndmask_b32 v7, 0, v12, vcc
  v_and_b32 v12, 15, v0
  v_lshlrev_b32 v12, 4, v12
  v_add_u32 v12, 106496, v12
  s_barrier
  s_waitcnt vmcnt(1)
  s_xor_b32 s53, s52, 2048
  buffer_load_dwordx4 v[52:55], v1, s[12:15], s53 offen nt
  s_waitcnt vmcnt(1)
  s_xor_b32 s53, s52, 3072
  buffer_load_dwordx4 v[56:59], v1, s[12:15], s53 offen nt
  s_cmp_lt_u32 s2, 43
  s_cbranch_scc1 L_kv_m
  s_cmp_eq_u32 s57, 1
  s_cbranch_scc1 L_kv_r
  s_xor_b32 s53, s52, 32768
  buffer_load_dwordx4 v[60:63], v1, s[12:15], s53 offen nt
  s_waitcnt vmcnt(2)
  s_xor_b32 s53, s52, 33792
  buffer_load_dwordx4 v[64:67], v1, s[12:15], s53 offen nt
  s_waitcnt vmcnt(2)
  s_xor_b32 s53, s52, 34816
  buffer_load_dwordx4 v[68:71], v1, s[12:15], s53 offen nt
  s_waitcnt vmcnt(2)
  s_xor_b32 s53, s52, 35840
  buffer_load_dwordx4 v[72:75], v1, s[12:15], s53 offen nt
  s_waitcnt vmcnt(2)
  s_xor_b32 s53, s52, 65536
  buffer_load_dwordx4 v[76:79], v1, s[12:15], s53 offen nt
  s_waitcnt vmcnt(2)
  s_xor_b32 s53, s52, 66560
  buffer_load_dwordx4 v[80:83], v1, s[12:15], s53 offen nt
  s_waitcnt vmcnt(2)
  s_xor_b32 s53, s52, 67584
  buffer_load_dwordx4 v[84:87], v1, s[12:15], s53 offen nt
  s_waitcnt vmcnt(2)
  s_xor_b32 s53, s52, 68608
  buffer_load_dwordx4 v[88:91], v1, s[12:15], s53 offen nt
  s_waitcnt vmcnt(2)
  s_xor_b32 s53, s52, 98304
  buffer_load_dwordx4 v[92:95], v1, s[12:15], s53 offen nt
  s_waitcnt vmcnt(2)
  s_xor_b32 s53, s52, 99328
  buffer_load_dwordx4 v[96:99], v1, s[12:15], s53 offen nt
  s_waitcnt vmcnt(2)
  s_xor_b32 s53, s52, 100352
  buffer_load_dwordx4 v[100:103], v1, s[12:15], s53 offen nt
  s_waitcnt vmcnt(2)
  s_xor_b32 s53, s52, 101376
  buffer_load_dwordx4 v[104:107], v1, s[12:15], s53 offen nt
  s_waitcnt vmcnt(2)
  s_xor_b32 s53, s52, 131072
  buffer_load_dwordx4 v[108:111], v1, s[12:15], s53 offen nt
  s_waitcnt vmcnt(2)
  s_xor_b32 s53, s52, 132096
  buffer_load_dwordx4 v[112:115], v1, s[12:15], s53 offen nt
  s_waitcnt vmcnt(2)
  s_xor_b32 s53, s52, 133120
  buffer_load_dwordx4 v[116:119], v1, s[12:15], s53 offen nt
  s_waitcnt vmcnt(2)
  s_xor_b32 s53, s52, 134144
  buffer_load_dwordx4 v[120:123], v1, s[12:15], s53 offen nt
  s_waitcnt vmcnt(2)
  s_xor_b32 s53, s52, 163840
  buffer_load_dwordx4 v[124:127], v1, s[12:15], s53 offen nt
  s_waitcnt vmcnt(2)
  s_xor_b32 s53, s52, 164864
  buffer_load_dwordx4 v[128:131], v1, s[12:15], s53 offen nt
  s_waitcnt vmcnt(2)
  s_xor_b32 s53, s52, 165888
  buffer_load_dwordx4 v[132:135], v1, s[12:15], s53 offen nt
  s_waitcnt vmcnt(2)
  s_xor_b32 s53, s52, 166912
  buffer_load_dwordx4 v[136:139], v1, s[12:15], s53 offen nt
  s_mov_b32 s75, 1000000
L_wqp:
  ds_read_b128 v[8:11], v12
  s_sub_u32 s75, s75, 1
  s_cbranch_scc1 L_wqp_ok
  s_waitcnt lgkmcnt(0)
  v_max3_u32 v13, v8, v9, v10
  v_max_u32 v13, v13, v11
  v_cmp_eq_u32 vcc, -1, v13
  s_cbranch_vccnz L_wqp
L_wqp_ok:
  s_waitcnt lgkmcnt(0)
  s_waitcnt vmcnt(2)
  s_xor_b32 s53, s52, 196608
  buffer_load_dwordx4 v[140:143], v1, s[12:15], s53 offen nt
  v_mov_b32 v24, 0
  v_mov_b32 v25, 0
  v_mov_b32 v26, 0
  v_mov_b32 v27, 0
  v_mov_b32 v28, 0
  v_mov_b32 v29, 0
  v_mov_b32 v30, 0
  v_mov_b32 v31, 0
  v_mov_b32 v32, 0
  v_mov_b32 v33, 0
  v_mov_b32 v34, 0
  v_mov_b32 v35, 0
  v_mov_b32 v36, 0
  v_mov_b32 v37, 0
  v_mov_b32 v38, 0
  v_mov_b32 v39, 0
  v_dot2c_f32_bf16 v24, v44, v8
  v_dot2c_f32_bf16 v24, v45, v9
  v_dot2c_f32_bf16 v24, v46, v10
  v_dot2c_f32_bf16 v24, v47, v11
  v_dot2c_f32_bf16 v25, v48, v8
  v_dot2c_f32_bf16 v25, v49, v9
  v_dot2c_f32_bf16 v25, v50, v10
  v_dot2c_f32_bf16 v25, v51, v11
  v_dot2c_f32_bf16 v26, v52, v8
  v_dot2c_f32_bf16 v26, v53, v9
  v_dot2c_f32_bf16 v26, v54, v10
  v_dot2c_f32_bf16 v26, v55, v11
  v_dot2c_f32_bf16 v27, v56, v8
  v_dot2c_f32_bf16 v27, v57, v9
  v_dot2c_f32_bf16 v27, v58, v10
  v_dot2c_f32_bf16 v27, v59, v11
  s_waitcnt vmcnt(2)
  s_xor_b32 s53, s52, 197632
  buffer_load_dwordx4 v[144:147], v1, s[12:15], s53 offen nt
  v_dot2c_f32_bf16 v28, v60, v8
  v_dot2c_f32_bf16 v28, v61, v9
  v_dot2c_f32_bf16 v28, v62, v10
  v_dot2c_f32_bf16 v28, v63, v11
  v_dot2c_f32_bf16 v29, v64, v8
  v_dot2c_f32_bf16 v29, v65, v9
  v_dot2c_f32_bf16 v29, v66, v10
  v_dot2c_f32_bf16 v29, v67, v11
  v_dot2c_f32_bf16 v30, v68, v8
  v_dot2c_f32_bf16 v30, v69, v9
  v_dot2c_f32_bf16 v30, v70, v10
  v_dot2c_f32_bf16 v30, v71, v11
  v_dot2c_f32_bf16 v31, v72, v8
  v_dot2c_f32_bf16 v31, v73, v9
  v_dot2c_f32_bf16 v31, v74, v10
  v_dot2c_f32_bf16 v31, v75, v11
  s_waitcnt vmcnt(2)
  s_xor_b32 s53, s52, 198656
  buffer_load_dwordx4 v[148:151], v1, s[12:15], s53 offen nt
  v_dot2c_f32_bf16 v32, v76, v8
  v_dot2c_f32_bf16 v32, v77, v9
  v_dot2c_f32_bf16 v32, v78, v10
  v_dot2c_f32_bf16 v32, v79, v11
  v_dot2c_f32_bf16 v33, v80, v8
  v_dot2c_f32_bf16 v33, v81, v9
  v_dot2c_f32_bf16 v33, v82, v10
  v_dot2c_f32_bf16 v33, v83, v11
  v_dot2c_f32_bf16 v34, v84, v8
  v_dot2c_f32_bf16 v34, v85, v9
  v_dot2c_f32_bf16 v34, v86, v10
  v_dot2c_f32_bf16 v34, v87, v11
  v_dot2c_f32_bf16 v35, v88, v8
  v_dot2c_f32_bf16 v35, v89, v9
  v_dot2c_f32_bf16 v35, v90, v10
  v_dot2c_f32_bf16 v35, v91, v11
  s_waitcnt vmcnt(2)
  s_xor_b32 s53, s52, 199680
  buffer_load_dwordx4 v[152:155], v1, s[12:15], s53 offen nt
  v_dot2c_f32_bf16 v36, v92, v8
  v_dot2c_f32_bf16 v36, v93, v9
  v_dot2c_f32_bf16 v36, v94, v10
  v_dot2c_f32_bf16 v36, v95, v11
  v_dot2c_f32_bf16 v37, v96, v8
  v_dot2c_f32_bf16 v37, v97, v9
  v_dot2c_f32_bf16 v37, v98, v10
  v_dot2c_f32_bf16 v37, v99, v11
  v_dot2c_f32_bf16 v38, v100, v8
  v_dot2c_f32_bf16 v38, v101, v9
  v_dot2c_f32_bf16 v38, v102, v10
  v_dot2c_f32_bf16 v38, v103, v11
  s_xor_b32 s53, s52, 229376
  buffer_load_dwordx4 v[156:159], v1, s[12:15], s53 offen nt
  v_dot2c_f32_bf16 v39, v104, v8
  v_dot2c_f32_bf16 v39, v105, v9
  v_dot2c_f32_bf16 v39, v106, v10
  v_dot2c_f32_bf16 v39, v107, v11
  v_add_f32_dpp v24, v24, v24 row_ror:8 row_mask:0xf bank_mask:0x3
  v_add_f32_dpp v25, v25, v25 row_ror:8 row_mask:0xf bank_mask:0x3
  v_add_f32_dpp v26, v26, v26 row_ror:8 row_mask:0xf bank_mask:0x3
  v_add_f32_dpp v27, v27, v27 row_ror:8 row_mask:0xf bank_mask:0x3
  v_add_f32_dpp v28, v28, v28 row_ror:8 row_mask:0xf bank_mask:0x3
  v_add_f32_dpp v29, v29, v29 row_ror:8 row_mask:0xf bank_mask:0x3
  v_add_f32_dpp v30, v30, v30 row_ror:8 row_mask:0xf bank_mask:0x3
  v_add_f32_dpp v31, v31, v31 row_ror:8 row_mask:0xf bank_mask:0x3
  v_add_f32_dpp v24, v32, v32 row_ror:8 row_mask:0xf bank_mask:0xc
  v_add_f32_dpp v25, v33, v33 row_ror:8 row_mask:0xf bank_mask:0xc
  v_add_f32_dpp v26, v34, v34 row_ror:8 row_mask:0xf bank_mask:0xc
  v_add_f32_dpp v27, v35, v35 row_ror:8 row_mask:0xf bank_mask:0xc
  v_add_f32_dpp v28, v36, v36 row_ror:8 row_mask:0xf bank_mask:0xc
  v_add_f32_dpp v29, v37, v37 row_ror:8 row_mask:0xf bank_mask:0xc
  v_add_f32_dpp v30, v38, v38 row_ror:8 row_mask:0xf bank_mask:0xc
  v_add_f32_dpp v31, v39, v39 row_ror:8 row_mask:0xf bank_mask:0xc
  v_add_f32_dpp v24, v24, v24 row_half_mirror row_mask:0xf bank_mask:0x5
  v_add_f32_dpp v25, v25, v25 row_half_mirror row_mask:0xf bank_mask:0x5
  v_add_f32_dpp v26, v26, v26 row_half_mirror row_mask:0xf bank_mask:0x5
  v_add_f32_dpp v27, v27, v27 row_half_mirror row_mask:0xf bank_mask:0x5
  v_add_f32_dpp v24, v28, v28 row_half_mirror row_mask:0xf bank_mask:0xa
  v_add_f32_dpp v25, v29, v29 row_half_mirror row_mask:0xf bank_mask:0xa
  v_add_f32_dpp v26, v30, v30 row_half_mirror row_mask:0xf bank_mask:0xa
  v_add_f32_dpp v27, v31, v31 row_half_mirror row_mask:0xf bank_mask:0xa
  v_add_f32_dpp v24, v24, v24 quad_perm:[2,3,0,1] row_mask:0xf bank_mask:0xf
  v_add_f32_dpp v25, v25, v25 quad_perm:[2,3,0,1] row_mask:0xf bank_mask:0xf
  v_add_f32_dpp v26, v26, v26 quad_perm:[2,3,0,1] row_mask:0xf bank_mask:0xf
  v_add_f32_dpp v27, v27, v27 quad_perm:[2,3,0,1] row_mask:0xf bank_mask:0xf
  v_cndmask_b32 v24, v24, v26, s[64:65]
  v_cndmask_b32 v25, v25, v27, s[64:65]
  s_nop 0
  v_add_f32_dpp v24, v24, v24 quad_perm:[1,0,3,2] row_mask:0xf bank_mask:0xf
  v_add_f32_dpp v25, v25, v25 quad_perm:[1,0,3,2] row_mask:0xf bank_mask:0xf
  v_cndmask_b32 v2, v24, v25, s[66:67]
  v_cvt_pk_bf16_f32 v2, v2, v2
  v_lshlrev_b32 v2, 16, v2
  v_mul_f32 v2, 0x3db504f3, v2
  v_cvt_pk_bf16_f32 v2, v2, v2
  v_lshlrev_b32 v2, 16, v2
  s_waitcnt vmcnt(3)
  v_mov_b32 v24, 0
  v_mov_b32 v25, 0
  v_mov_b32 v26, 0
  v_mov_b32 v27, 0
  v_mov_b32 v28, 0
  v_mov_b32 v29, 0
  v_mov_b32 v30, 0
  v_mov_b32 v31, 0
  v_mov_b32 v32, 0
  v_mov_b32 v33, 0
  v_mov_b32 v34, 0
  v_mov_b32 v35, 0
  v_mov_b32 v36, 0
  v_mov_b32 v37, 0
  v_mov_b32 v38, 0
  v_mov_b32 v39, 0
  v_dot2c_f32_bf16 v24, v108, v8
  v_dot2c_f32_bf16 v24, v109, v9
  v_dot2c_f32_bf16 v24, v110, v10
  v_dot2c_f32_bf16 v24, v111, v11
  v_dot2c_f32_bf16 v25, v112, v8
  v_dot2c_f32_bf16 v25, v113, v9
  v_dot2c_f32_bf16 v25, v114, v10
  v_dot2c_f32_bf16 v25, v115, v11
  v_dot2c_f32_bf16 v26, v116, v8
  v_dot2c_f32_bf16 v26, v117, v9
  v_dot2c_f32_bf16 v26, v118, v10
  v_dot2c_f32_bf16 v26, v119, v11
  v_dot2c_f32_bf16 v27, v120, v8
  v_dot2c_f32_bf16 v27, v121, v9
  v_dot2c_f32_bf16 v27, v122, v10
  v_dot2c_f32_bf16 v27, v123, v11
  s_waitcnt vmcnt(2)
  s_xor_b32 s53, s52, 230400
  buffer_load_dwordx4 v[160:163], v1, s[12:15], s53 offen nt
  v_dot2c_f32_bf16 v28, v124, v8
  v_dot2c_f32_bf16 v28, v125, v9
  v_dot2c_f32_bf16 v28, v126, v10
  v_dot2c_f32_bf16 v28, v127, v11
  v_dot2c_f32_bf16 v29, v128, v8
  v_dot2c_f32_bf16 v29, v129, v9
  v_dot2c_f32_bf16 v29, v130, v10
  v_dot2c_f32_bf16 v29, v131, v11
  v_dot2c_f32_bf16 v30, v132, v8
  v_dot2c_f32_bf16 v30, v133, v9
  v_dot2c_f32_bf16 v30, v134, v10
  v_dot2c_f32_bf16 v30, v135, v11
  v_dot2c_f32_bf16 v31, v136, v8
  v_dot2c_f32_bf16 v31, v137, v9
  v_dot2c_f32_bf16 v31, v138, v10
  v_dot2c_f32_bf16 v31, v139, v11
  s_waitcnt vmcnt(2)
  s_xor_b32 s53, s52, 231424
  buffer_load_dwordx4 v[164:167], v1, s[12:15], s53 offen nt
  v_dot2c_f32_bf16 v32, v140, v8
  v_dot2c_f32_bf16 v32, v141, v9
  v_dot2c_f32_bf16 v32, v142, v10
  v_dot2c_f32_bf16 v32, v143, v11
  v_dot2c_f32_bf16 v33, v144, v8
  v_dot2c_f32_bf16 v33, v145, v9
  v_dot2c_f32_bf16 v33, v146, v10
  v_dot2c_f32_bf16 v33, v147, v11
  v_dot2c_f32_bf16 v34, v148, v8
  v_dot2c_f32_bf16 v34, v149, v9
  v_dot2c_f32_bf16 v34, v150, v10
  v_dot2c_f32_bf16 v34, v151, v11
  v_dot2c_f32_bf16 v35, v152, v8
  v_dot2c_f32_bf16 v35, v153, v9
  v_dot2c_f32_bf16 v35, v154, v10
  v_dot2c_f32_bf16 v35, v155, v11
  s_waitcnt vmcnt(2)
  s_xor_b32 s53, s52, 232448
  buffer_load_dwordx4 v[44:47], v1, s[12:15], s53 offen nt
  v_dot2c_f32_bf16 v36, v156, v8
  v_dot2c_f32_bf16 v36, v157, v9
  v_dot2c_f32_bf16 v36, v158, v10
  v_dot2c_f32_bf16 v36, v159, v11
  s_waitcnt vmcnt(2)
  buffer_load_dwordx4 v[48:51], v1, s[16:19], s52 offen nt
  v_dot2c_f32_bf16 v37, v160, v8
  v_dot2c_f32_bf16 v37, v161, v9
  v_dot2c_f32_bf16 v37, v162, v10
  v_dot2c_f32_bf16 v37, v163, v11
  s_waitcnt vmcnt(2)
  s_xor_b32 s53, s52, 1024
  buffer_load_dwordx4 v[52:55], v1, s[16:19], s53 offen nt
  v_dot2c_f32_bf16 v38, v164, v8
  v_dot2c_f32_bf16 v38, v165, v9
  v_dot2c_f32_bf16 v38, v166, v10
  v_dot2c_f32_bf16 v38, v167, v11
  s_waitcnt vmcnt(2)
  s_xor_b32 s53, s52, 2048
  buffer_load_dwordx4 v[56:59], v1, s[16:19], s53 offen nt
  s_xor_b32 s53, s52, 3072
  buffer_load_dwordx4 v[60:63], v1, s[16:19], s53 offen nt
  v_dot2c_f32_bf16 v39, v44, v8
  v_dot2c_f32_bf16 v39, v45, v9
  v_dot2c_f32_bf16 v39, v46, v10
  v_dot2c_f32_bf16 v39, v47, v11
  v_add_f32_dpp v24, v24, v24 row_ror:8 row_mask:0xf bank_mask:0x3
  v_add_f32_dpp v25, v25, v25 row_ror:8 row_mask:0xf bank_mask:0x3
  v_add_f32_dpp v26, v26, v26 row_ror:8 row_mask:0xf bank_mask:0x3
  v_add_f32_dpp v27, v27, v27 row_ror:8 row_mask:0xf bank_mask:0x3
  v_add_f32_dpp v28, v28, v28 row_ror:8 row_mask:0xf bank_mask:0x3
  v_add_f32_dpp v29, v29, v29 row_ror:8 row_mask:0xf bank_mask:0x3
  v_add_f32_dpp v30, v30, v30 row_ror:8 row_mask:0xf bank_mask:0x3
  v_add_f32_dpp v31, v31, v31 row_ror:8 row_mask:0xf bank_mask:0x3
  v_add_f32_dpp v24, v32, v32 row_ror:8 row_mask:0xf bank_mask:0xc
  v_add_f32_dpp v25, v33, v33 row_ror:8 row_mask:0xf bank_mask:0xc
  v_add_f32_dpp v26, v34, v34 row_ror:8 row_mask:0xf bank_mask:0xc
  v_add_f32_dpp v27, v35, v35 row_ror:8 row_mask:0xf bank_mask:0xc
  v_add_f32_dpp v28, v36, v36 row_ror:8 row_mask:0xf bank_mask:0xc
  v_add_f32_dpp v29, v37, v37 row_ror:8 row_mask:0xf bank_mask:0xc
  v_add_f32_dpp v30, v38, v38 row_ror:8 row_mask:0xf bank_mask:0xc
  v_add_f32_dpp v31, v39, v39 row_ror:8 row_mask:0xf bank_mask:0xc
  v_add_f32_dpp v24, v24, v24 row_half_mirror row_mask:0xf bank_mask:0x5
  v_add_f32_dpp v25, v25, v25 row_half_mirror row_mask:0xf bank_mask:0x5
  v_add_f32_dpp v26, v26, v26 row_half_mirror row_mask:0xf bank_mask:0x5
  v_add_f32_dpp v27, v27, v27 row_half_mirror row_mask:0xf bank_mask:0x5
  v_add_f32_dpp v24, v28, v28 row_half_mirror row_mask:0xf bank_mask:0xa
  v_add_f32_dpp v25, v29, v29 row_half_mirror row_mask:0xf bank_mask:0xa
  v_add_f32_dpp v26, v30, v30 row_half_mirror row_mask:0xf bank_mask:0xa
  v_add_f32_dpp v27, v31, v31 row_half_mirror row_mask:0xf bank_mask:0xa
  v_add_f32_dpp v24, v24, v24 quad_perm:[2,3,0,1] row_mask:0xf bank_mask:0xf
  v_add_f32_dpp v25, v25, v25 quad_perm:[2,3,0,1] row_mask:0xf bank_mask:0xf
  v_add_f32_dpp v26, v26, v26 quad_perm:[2,3,0,1] row_mask:0xf bank_mask:0xf
  v_add_f32_dpp v27, v27, v27 quad_perm:[2,3,0,1] row_mask:0xf bank_mask:0xf
  v_cndmask_b32 v24, v24, v26, s[64:65]
  v_cndmask_b32 v25, v25, v27, s[64:65]
  s_nop 0
  v_add_f32_dpp v24, v24, v24 quad_perm:[1,0,3,2] row_mask:0xf bank_mask:0xf
  v_add_f32_dpp v25, v25, v25 quad_perm:[1,0,3,2] row_mask:0xf bank_mask:0xf
  v_cndmask_b32 v3, v24, v25, s[66:67]
  v_cvt_pk_bf16_f32 v3, v3, v3
  v_lshlrev_b32 v3, 16, v3
  v_mul_f32 v3, 0x3db504f3, v3
  v_cvt_pk_bf16_f32 v3, v3, v3
  v_lshlrev_b32 v3, 16, v3
  v_max_f32 v24, v2, v3
  s_nop 1
  v_max_f32_dpp v24, v24, v24 row_shr:1 row_mask:0xf bank_mask:0xf
  s_nop 1
  v_max_f32_dpp v24, v24, v24 row_shr:2 row_mask:0xf bank_mask:0xf
  s_nop 1
  v_max_f32_dpp v24, v24, v24 row_shr:4 row_mask:0xf bank_mask:0xf
  s_nop 1
  v_max_f32_dpp v24, v24, v24 row_shr:8 row_mask:0xf bank_mask:0xf
  s_nop 1
  v_max_f32_dpp v24, v24, v24 row_bcast:15 row_mask:0xa bank_mask:0xf
  s_nop 1
  v_max_f32_dpp v24, v24, v24 row_bcast:31 row_mask:0xc bank_mask:0xf
  s_nop 0
  v_readlane_b32 s72, v24, 63
  s_nop 1
  v_subrev_f32 v2, s72, v2
  v_subrev_f32 v3, s72, v3
  v_mul_f32 v2, 0x3fb8aa3b, v2
  v_mul_f32 v3, 0x3fb8aa3b, v3
  v_exp_f32 v2, v2
  v_exp_f32 v3, v3
  s_nop 0
  v_add_f32 v25, v2, v3
  v_cvt_pk_bf16_f32 v2, v2, v2
  v_cvt_pk_bf16_f32 v3, v3, v3
  v_add_f32_dpp v25, v25, v25 row_shr:1 row_mask:0xf bank_mask:0xf
  s_nop 1
  v_add_f32_dpp v25, v25, v25 row_shr:2 row_mask:0xf bank_mask:0xf
  s_nop 1
  v_add_f32_dpp v25, v25, v25 row_shr:4 row_mask:0xf bank_mask:0xf
  s_nop 1
  v_add_f32_dpp v25, v25, v25 row_shr:8 row_mask:0xf bank_mask:0xf
  s_nop 1
  v_add_f32_dpp v25, v25, v25 row_bcast:15 row_mask:0xa bank_mask:0xf
  s_nop 1
  v_add_f32_dpp v25, v25, v25 row_bcast:31 row_mask:0xc bank_mask:0xf
  s_lshl_b32 s73, s3, 3
  s_add_u32 s73, s73, 106752
  v_mov_b32 v26, s73
  s_mov_b32 exec_lo, 0
  s_mov_b32 exec_hi, 0x80000000
  ds_write_b64 v26, v[24:25]
  s_mov_b64 exec, -1
  s_lshl_b32 s73, s3, 9
  s_add_u32 s73, s73, 100352
  v_and_b32 v27, 15, v0
  v_lshrrev_b32 v28, 4, v0
  v_lshlrev_b32 v29, 5, v27
  v_lshl_add_u32 v29, v28, 4, v29
  v_add_u32 v29, s73, v29
  v_and_b32_dpp v12, v2, v4 row_newbcast:0 row_mask:0xf bank_mask:0xf
  v_and_b32_dpp v13, v2, v5 row_newbcast:0 row_mask:0xf bank_mask:0xf
  v_and_b32_dpp v14, v2, v6 row_newbcast:0 row_mask:0xf bank_mask:0xf
  v_and_b32_dpp v15, v2, v7 row_newbcast:0 row_mask:0xf bank_mask:0xf
  s_waitcnt vmcnt(3)
  s_nop 0
  v_mfma_f32_16x16x32_bf16 v[20:23], v[12:15], v[48:51], 0
  v_and_b32_dpp v16, v2, v4 row_newbcast:1 row_mask:0xf bank_mask:0xf
  v_and_b32_dpp v17, v2, v5 row_newbcast:1 row_mask:0xf bank_mask:0xf
  v_and_b32_dpp v18, v2, v6 row_newbcast:1 row_mask:0xf bank_mask:0xf
  v_and_b32_dpp v19, v2, v7 row_newbcast:1 row_mask:0xf bank_mask:0xf
  s_waitcnt vmcnt(2)
  s_xor_b32 s53, s52, 32768
  buffer_load_dwordx4 v[64:67], v1, s[16:19], s53 offen nt
  v_mfma_f32_16x16x32_bf16 v[20:23], v[16:19], v[52:55], v[20:23]
  v_and_b32_dpp v12, v2, v4 row_newbcast:2 row_mask:0xf bank_mask:0xf
  v_and_b32_dpp v13, v2, v5 row_newbcast:2 row_mask:0xf bank_mask:0xf
  v_and_b32_dpp v14, v2, v6 row_newbcast:2 row_mask:0xf bank_mask:0xf
  v_and_b32_dpp v15, v2, v7 row_newbcast:2 row_mask:0xf bank_mask:0xf
  s_waitcnt vmcnt(2)
  s_xor_b32 s53, s52, 33792
  buffer_load_dwordx4 v[68:71], v1, s[16:19], s53 offen nt
  v_mfma_f32_16x16x32_bf16 v[20:23], v[12:15], v[56:59], v[20:23]
  v_and_b32_dpp v16, v2, v4 row_newbcast:3 row_mask:0xf bank_mask:0xf
  v_and_b32_dpp v17, v2, v5 row_newbcast:3 row_mask:0xf bank_mask:0xf
  v_and_b32_dpp v18, v2, v6 row_newbcast:3 row_mask:0xf bank_mask:0xf
  v_and_b32_dpp v19, v2, v7 row_newbcast:3 row_mask:0xf bank_mask:0xf
  s_waitcnt vmcnt(2)
  s_xor_b32 s53, s52, 34816
  buffer_load_dwordx4 v[72:75], v1, s[16:19], s53 offen nt
  v_mfma_f32_16x16x32_bf16 v[20:23], v[16:19], v[60:63], v[20:23]
  v_and_b32_dpp v12, v2, v4 row_newbcast:4 row_mask:0xf bank_mask:0xf
  v_and_b32_dpp v13, v2, v5 row_newbcast:4 row_mask:0xf bank_mask:0xf
  v_and_b32_dpp v14, v2, v6 row_newbcast:4 row_mask:0xf bank_mask:0xf
  v_and_b32_dpp v15, v2, v7 row_newbcast:4 row_mask:0xf bank_mask:0xf
  s_waitcnt vmcnt(2)
  s_xor_b32 s53, s52, 35840
  buffer_load_dwordx4 v[76:79], v1, s[16:19], s53 offen nt
  v_mfma_f32_16x16x32_bf16 v[20:23], v[12:15], v[64:67], v[20:23]
  v_and_b32_dpp v16, v2, v4 row_newbcast:5 row_mask:0xf bank_mask:0xf
  v_and_b32_dpp v17, v2, v5 row_newbcast:5 row_mask:0xf bank_mask:0xf
  v_and_b32_dpp v18, v2, v6 row_newbcast:5 row_mask:0xf bank_mask:0xf
  v_and_b32_dpp v19, v2, v7 row_newbcast:5 row_mask:0xf bank_mask:0xf
  s_waitcnt vmcnt(2)
  s_xor_b32 s53, s52, 65536
  buffer_load_dwordx4 v[80:83], v1, s[16:19], s53 offen nt
  v_mfma_f32_16x16x32_bf16 v[20:23], v[16:19], v[68:71], v[20:23]
  v_and_b32_dpp v12, v2, v4 row_newbcast:6 row_mask:0xf bank_mask:0xf
  v_and_b32_dpp v13, v2, v5 row_newbcast:6 row_mask:0xf bank_mask:0xf
  v_and_b32_dpp v14, v2, v6 row_newbcast:6 row_mask:0xf bank_mask:0xf
  v_and_b32_dpp v15, v2, v7 row_newbcast:6 row_mask:0xf bank_mask:0xf
  s_waitcnt vmcnt(2)
  s_xor_b32 s53, s52, 66560
  buffer_load_dwordx4 v[84:87], v1, s[16:19], s53 offen nt
  v_mfma_f32_16x16x32_bf16 v[20:23], v[12:15], v[72:75], v[20:23]
  v_and_b32_dpp v16, v2, v4 row_newbcast:7 row_mask:0xf bank_mask:0xf
  v_and_b32_dpp v17, v2, v5 row_newbcast:7 row_mask:0xf bank_mask:0xf
  v_and_b32_dpp v18, v2, v6 row_newbcast:7 row_mask:0xf bank_mask:0xf
  v_and_b32_dpp v19, v2, v7 row_newbcast:7 row_mask:0xf bank_mask:0xf
  s_waitcnt vmcnt(2)
  s_xor_b32 s53, s52, 67584
  buffer_load_dwordx4 v[88:91], v1, s[16:19], s53 offen nt
  v_mfma_f32_16x16x32_bf16 v[20:23], v[16:19], v[76:79], v[20:23]
  v_and_b32_dpp v12, v2, v4 row_newbcast:8 row_mask:0xf bank_mask:0xf
  v_and_b32_dpp v13, v2, v5 row_newbcast:8 row_mask:0xf bank_mask:0xf
  v_and_b32_dpp v14, v2, v6 row_newbcast:8 row_mask:0xf bank_mask:0xf
  v_and_b32_dpp v15, v2, v7 row_newbcast:8 row_mask:0xf bank_mask:0xf
  s_waitcnt vmcnt(2)
  s_xor_b32 s53, s52, 68608
  buffer_load_dwordx4 v[92:95], v1, s[16:19], s53 offen nt
  v_mfma_f32_16x16x32_bf16 v[20:23], v[12:15], v[80:83], v[20:23]
  v_and_b32_dpp v16, v2, v4 row_newbcast:9 row_mask:0xf bank_mask:0xf
  v_and_b32_dpp v17, v2, v5 row_newbcast:9 row_mask:0xf bank_mask:0xf
  v_and_b32_dpp v18, v2, v6 row_newbcast:9 row_mask:0xf bank_mask:0xf
  v_and_b32_dpp v19, v2, v7 row_newbcast:9 row_mask:0xf bank_mask:0xf
  s_waitcnt vmcnt(2)
  s_xor_b32 s53, s52, 98304
  buffer_load_dwordx4 v[96:99], v1, s[16:19], s53 offen nt
  v_mfma_f32_16x16x32_bf16 v[20:23], v[16:19], v[84:87], v[20:23]
  v_and_b32_dpp v12, v2, v4 row_newbcast:10 row_mask:0xf bank_mask:0xf
  v_and_b32_dpp v13, v2, v5 row_newbcast:10 row_mask:0xf bank_mask:0xf
  v_and_b32_dpp v14, v2, v6 row_newbcast:10 row_mask:0xf bank_mask:0xf
  v_and_b32_dpp v15, v2, v7 row_newbcast:10 row_mask:0xf bank_mask:0xf
  s_waitcnt vmcnt(2)
  s_xor_b32 s53, s52, 99328
  buffer_load_dwordx4 v[100:103], v1, s[16:19], s53 offen nt
  v_mfma_f32_16x16x32_bf16 v[20:23], v[12:15], v[88:91], v[20:23]
  v_and_b32_dpp v16, v2, v4 row_newbcast:11 row_mask:0xf bank_mask:0xf
  v_and_b32_dpp v17, v2, v5 row_newbcast:11 row_mask:0xf bank_mask:0xf
  v_and_b32_dpp v18, v2, v6 row_newbcast:11 row_mask:0xf bank_mask:0xf
  v_and_b32_dpp v19, v2, v7 row_newbcast:11 row_mask:0xf bank_mask:0xf
  s_waitcnt vmcnt(2)
  s_xor_b32 s53, s52, 100352
  buffer_load_dwordx4 v[104:107], v1, s[16:19], s53 offen nt
  v_mfma_f32_16x16x32_bf16 v[20:23], v[16:19], v[92:95], v[20:23]
  v_and_b32_dpp v12, v2, v4 row_newbcast:12 row_mask:0xf bank_mask:0xf
  v_and_b32_dpp v13, v2, v5 row_newbcast:12 row_mask:0xf bank_mask:0xf
  v_and_b32_dpp v14, v2, v6 row_newbcast:12 row_mask:0xf bank_mask:0xf
  v_and_b32_dpp v15, v2, v7 row_newbcast:12 row_mask:0xf bank_mask:0xf
  s_waitcnt vmcnt(2)
  s_xor_b32 s53, s52, 101376
  buffer_load_dwordx4 v[108:111], v1, s[16:19], s53 offen nt
  v_mfma_f32_16x16x32_bf16 v[20:23], v[12:15], v[96:99], v[20:23]
  v_and_b32_dpp v16, v2, v4 row_newbcast:13 row_mask:0xf bank_mask:0xf
  v_and_b32_dpp v17, v2, v5 row_newbcast:13 row_mask:0xf bank_mask:0xf
  v_and_b32_dpp v18, v2, v6 row_newbcast:13 row_mask:0xf bank_mask:0xf
  v_and_b32_dpp v19, v2, v7 row_newbcast:13 row_mask:0xf bank_mask:0xf
  s_waitcnt vmcnt(2)
  s_xor_b32 s53, s52, 131072
  buffer_load_dwordx4 v[112:115], v1, s[16:19], s53 offen nt
  v_mfma_f32_16x16x32_bf16 v[20:23], v[16:19], v[100:103], v[20:23]
  v_and_b32_dpp v12, v2, v4 row_newbcast:14 row_mask:0xf bank_mask:0xf
  v_and_b32_dpp v13, v2, v5 row_newbcast:14 row_mask:0xf bank_mask:0xf
  v_and_b32_dpp v14, v2, v6 row_newbcast:14 row_mask:0xf bank_mask:0xf
  v_and_b32_dpp v15, v2, v7 row_newbcast:14 row_mask:0xf bank_mask:0xf
  s_waitcnt vmcnt(2)
  s_xor_b32 s53, s52, 132096
  buffer_load_dwordx4 v[116:119], v1, s[16:19], s53 offen nt
  v_mfma_f32_16x16x32_bf16 v[20:23], v[12:15], v[104:107], v[20:23]
  v_and_b32_dpp v16, v2, v4 row_newbcast:15 row_mask:0xf bank_mask:0xf
  v_and_b32_dpp v17, v2, v5 row_newbcast:15 row_mask:0xf bank_mask:0xf
  v_and_b32_dpp v18, v2, v6 row_newbcast:15 row_mask:0xf bank_mask:0xf
  v_and_b32_dpp v19, v2, v7 row_newbcast:15 row_mask:0xf bank_mask:0xf
  s_waitcnt vmcnt(2)
  s_xor_b32 s53, s52, 133120
  buffer_load_dwordx4 v[120:123], v1, s[16:19], s53 offen nt
  v_mfma_f32_16x16x32_bf16 v[20:23], v[16:19], v[108:111], v[20:23]
  v_and_b32_dpp v12, v3, v4 row_newbcast:0 row_mask:0xf bank_mask:0xf
  v_and_b32_dpp v13, v3, v5 row_newbcast:0 row_mask:0xf bank_mask:0xf
  v_and_b32_dpp v14, v3, v6 row_newbcast:0 row_mask:0xf bank_mask:0xf
  v_and_b32_dpp v15, v3, v7 row_newbcast:0 row_mask:0xf bank_mask:0xf
  s_waitcnt vmcnt(2)
  s_xor_b32 s53, s52, 134144
  buffer_load_dwordx4 v[124:127], v1, s[16:19], s53 offen nt
  v_mfma_f32_16x16x32_bf16 v[20:23], v[12:15], v[112:115], v[20:23]
  v_and_b32_dpp v16, v3, v4 row_newbcast:1 row_mask:0xf bank_mask:0xf
  v_and_b32_dpp v17, v3, v5 row_newbcast:1 row_mask:0xf bank_mask:0xf
  v_and_b32_dpp v18, v3, v6 row_newbcast:1 row_mask:0xf bank_mask:0xf
  v_and_b32_dpp v19, v3, v7 row_newbcast:1 row_mask:0xf bank_mask:0xf
  s_waitcnt vmcnt(2)
  s_xor_b32 s53, s52, 163840
  buffer_load_dwordx4 v[128:131], v1, s[16:19], s53 offen nt
  v_mfma_f32_16x16x32_bf16 v[20:23], v[16:19], v[116:119], v[20:23]
  v_and_b32_dpp v12, v3, v4 row_newbcast:2 row_mask:0xf bank_mask:0xf
  v_and_b32_dpp v13, v3, v5 row_newbcast:2 row_mask:0xf bank_mask:0xf
  v_and_b32_dpp v14, v3, v6 row_newbcast:2 row_mask:0xf bank_mask:0xf
  v_and_b32_dpp v15, v3, v7 row_newbcast:2 row_mask:0xf bank_mask:0xf
  s_waitcnt vmcnt(2)
  s_xor_b32 s53, s52, 164864
  buffer_load_dwordx4 v[132:135], v1, s[16:19], s53 offen nt
  v_mfma_f32_16x16x32_bf16 v[20:23], v[12:15], v[120:123], v[20:23]
  v_and_b32_dpp v16, v3, v4 row_newbcast:3 row_mask:0xf bank_mask:0xf
  v_and_b32_dpp v17, v3, v5 row_newbcast:3 row_mask:0xf bank_mask:0xf
  v_and_b32_dpp v18, v3, v6 row_newbcast:3 row_mask:0xf bank_mask:0xf
  v_and_b32_dpp v19, v3, v7 row_newbcast:3 row_mask:0xf bank_mask:0xf
  s_waitcnt vmcnt(2)
  s_xor_b32 s53, s52, 165888
  buffer_load_dwordx4 v[136:139], v1, s[16:19], s53 offen nt
  v_mfma_f32_16x16x32_bf16 v[20:23], v[16:19], v[124:127], v[20:23]
  v_and_b32_dpp v12, v3, v4 row_newbcast:4 row_mask:0xf bank_mask:0xf
  v_and_b32_dpp v13, v3, v5 row_newbcast:4 row_mask:0xf bank_mask:0xf
  v_and_b32_dpp v14, v3, v6 row_newbcast:4 row_mask:0xf bank_mask:0xf
  v_and_b32_dpp v15, v3, v7 row_newbcast:4 row_mask:0xf bank_mask:0xf
  s_waitcnt vmcnt(2)
  s_xor_b32 s53, s52, 166912
  buffer_load_dwordx4 v[140:143], v1, s[16:19], s53 offen nt
  v_mfma_f32_16x16x32_bf16 v[20:23], v[12:15], v[128:131], v[20:23]
  v_and_b32_dpp v16, v3, v4 row_newbcast:5 row_mask:0xf bank_mask:0xf
  v_and_b32_dpp v17, v3, v5 row_newbcast:5 row_mask:0xf bank_mask:0xf
  v_and_b32_dpp v18, v3, v6 row_newbcast:5 row_mask:0xf bank_mask:0xf
  v_and_b32_dpp v19, v3, v7 row_newbcast:5 row_mask:0xf bank_mask:0xf
  s_waitcnt vmcnt(2)
  s_xor_b32 s53, s52, 196608
  buffer_load_dwordx4 v[144:147], v1, s[16:19], s53 offen nt
  v_mfma_f32_16x16x32_bf16 v[20:23], v[16:19], v[132:135], v[20:23]
  v_and_b32_dpp v12, v3, v4 row_newbcast:6 row_mask:0xf bank_mask:0xf
  v_and_b32_dpp v13, v3, v5 row_newbcast:6 row_mask:0xf bank_mask:0xf
  v_and_b32_dpp v14, v3, v6 row_newbcast:6 row_mask:0xf bank_mask:0xf
  v_and_b32_dpp v15, v3, v7 row_newbcast:6 row_mask:0xf bank_mask:0xf
  s_waitcnt vmcnt(2)
  s_xor_b32 s53, s52, 197632
  buffer_load_dwordx4 v[148:151], v1, s[16:19], s53 offen nt
  v_mfma_f32_16x16x32_bf16 v[20:23], v[12:15], v[136:139], v[20:23]
  v_and_b32_dpp v16, v3, v4 row_newbcast:7 row_mask:0xf bank_mask:0xf
  v_and_b32_dpp v17, v3, v5 row_newbcast:7 row_mask:0xf bank_mask:0xf
  v_and_b32_dpp v18, v3, v6 row_newbcast:7 row_mask:0xf bank_mask:0xf
  v_and_b32_dpp v19, v3, v7 row_newbcast:7 row_mask:0xf bank_mask:0xf
  s_waitcnt vmcnt(2)
  s_xor_b32 s53, s52, 198656
  buffer_load_dwordx4 v[152:155], v1, s[16:19], s53 offen nt
  v_mfma_f32_16x16x32_bf16 v[20:23], v[16:19], v[140:143], v[20:23]
  v_and_b32_dpp v12, v3, v4 row_newbcast:8 row_mask:0xf bank_mask:0xf
  v_and_b32_dpp v13, v3, v5 row_newbcast:8 row_mask:0xf bank_mask:0xf
  v_and_b32_dpp v14, v3, v6 row_newbcast:8 row_mask:0xf bank_mask:0xf
  v_and_b32_dpp v15, v3, v7 row_newbcast:8 row_mask:0xf bank_mask:0xf
  s_waitcnt vmcnt(2)
  s_xor_b32 s53, s52, 199680
  buffer_load_dwordx4 v[156:159], v1, s[16:19], s53 offen nt
  v_mfma_f32_16x16x32_bf16 v[20:23], v[12:15], v[144:147], v[20:23]
  v_and_b32_dpp v16, v3, v4 row_newbcast:9 row_mask:0xf bank_mask:0xf
  v_and_b32_dpp v17, v3, v5 row_newbcast:9 row_mask:0xf bank_mask:0xf
  v_and_b32_dpp v18, v3, v6 row_newbcast:9 row_mask:0xf bank_mask:0xf
  v_and_b32_dpp v19, v3, v7 row_newbcast:9 row_mask:0xf bank_mask:0xf
  s_waitcnt vmcnt(2)
  s_xor_b32 s53, s52, 229376
  buffer_load_dwordx4 v[160:163], v1, s[16:19], s53 offen nt
  v_mfma_f32_16x16x32_bf16 v[20:23], v[16:19], v[148:151], v[20:23]
  v_and_b32_dpp v12, v3, v4 row_newbcast:10 row_mask:0xf bank_mask:0xf
  v_and_b32_dpp v13, v3, v5 row_newbcast:10 row_mask:0xf bank_mask:0xf
  v_and_b32_dpp v14, v3, v6 row_newbcast:10 row_mask:0xf bank_mask:0xf
  v_and_b32_dpp v15, v3, v7 row_newbcast:10 row_mask:0xf bank_mask:0xf
  s_waitcnt vmcnt(2)
  s_xor_b32 s53, s52, 230400
  buffer_load_dwordx4 v[164:167], v1, s[16:19], s53 offen nt
  v_mfma_f32_16x16x32_bf16 v[20:23], v[12:15], v[152:155], v[20:23]
  v_and_b32_dpp v16, v3, v4 row_newbcast:11 row_mask:0xf bank_mask:0xf
  v_and_b32_dpp v17, v3, v5 row_newbcast:11 row_mask:0xf bank_mask:0xf
  v_and_b32_dpp v18, v3, v6 row_newbcast:11 row_mask:0xf bank_mask:0xf
  v_and_b32_dpp v19, v3, v7 row_newbcast:11 row_mask:0xf bank_mask:0xf
  s_waitcnt vmcnt(2)
  s_xor_b32 s53, s52, 231424
  buffer_load_dwordx4 v[44:47], v1, s[16:19], s53 offen nt
  v_mfma_f32_16x16x32_bf16 v[20:23], v[16:19], v[156:159], v[20:23]
  v_and_b32_dpp v12, v3, v4 row_newbcast:12 row_mask:0xf bank_mask:0xf
  v_and_b32_dpp v13, v3, v5 row_newbcast:12 row_mask:0xf bank_mask:0xf
  v_and_b32_dpp v14, v3, v6 row_newbcast:12 row_mask:0xf bank_mask:0xf
  v_and_b32_dpp v15, v3, v7 row_newbcast:12 row_mask:0xf bank_mask:0xf
  s_waitcnt vmcnt(2)
  s_xor_b32 s53, s52, 232448
  buffer_load_dwordx4 v[48:51], v1, s[16:19], s53 offen nt
  v_mfma_f32_16x16x32_bf16 v[20:23], v[12:15], v[160:163], v[20:23]
  v_and_b32_dpp v16, v3, v4 row_newbcast:13 row_mask:0xf bank_mask:0xf
  v_and_b32_dpp v17, v3, v5 row_newbcast:13 row_mask:0xf bank_mask:0xf
  v_and_b32_dpp v18, v3, v6 row_newbcast:13 row_mask:0xf bank_mask:0xf
  v_and_b32_dpp v19, v3, v7 row_newbcast:13 row_mask:0xf bank_mask:0xf
  s_waitcnt vmcnt(2)
  s_nop 0
  v_mfma_f32_16x16x32_bf16 v[20:23], v[16:19], v[164:167], v[20:23]
  v_and_b32_dpp v12, v3, v4 row_newbcast:14 row_mask:0xf bank_mask:0xf
  v_and_b32_dpp v13, v3, v5 row_newbcast:14 row_mask:0xf bank_mask:0xf
  v_and_b32_dpp v14, v3, v6 row_newbcast:14 row_mask:0xf bank_mask:0xf
  v_and_b32_dpp v15, v3, v7 row_newbcast:14 row_mask:0xf bank_mask:0xf
  s_waitcnt vmcnt(1)
  s_nop 0
  v_mfma_f32_16x16x32_bf16 v[20:23], v[12:15], v[44:47], v[20:23]
  v_and_b32_dpp v16, v3, v4 row_newbcast:15 row_mask:0xf bank_mask:0xf
  v_and_b32_dpp v17, v3, v5 row_newbcast:15 row_mask:0xf bank_mask:0xf
  v_and_b32_dpp v18, v3, v6 row_newbcast:15 row_mask:0xf bank_mask:0xf
  v_and_b32_dpp v19, v3, v7 row_newbcast:15 row_mask:0xf bank_mask:0xf
  s_waitcnt vmcnt(0)
  s_nop 0
  v_mfma_f32_16x16x32_bf16 v[20:23], v[16:19], v[48:51], v[20:23]
  s_mov_b32 exec_hi, 0
  s_nop 6
  ds_write_b128 v29, v[20:23]
  s_mov_b64 exec, -1
  s_branch L_fin
L_kv_r:
  s_load_dwordx2 s[20:21], s[0:1], 32
  s_mov_b32 s22, 4194304
  s_mov_b32 s23, 0x20000
  s_xor_b32 s53, s52, 32768
  buffer_load_dwordx4 v[60:63], v1, s[12:15], s53 offen nt
  s_xor_b32 s53, s52, 33792
  buffer_load_dwordx4 v[64:67], v1, s[12:15], s53 offen nt
  s_waitcnt vmcnt(3)
  s_xor_b32 s53, s52, 34816
  buffer_load_dwordx4 v[68:71], v1, s[12:15], s53 offen nt
  s_waitcnt vmcnt(3)
  s_xor_b32 s53, s52, 35840
  buffer_load_dwordx4 v[72:75], v1, s[12:15], s53 offen nt
  s_waitcnt vmcnt(3)
  s_xor_b32 s53, s52, 65536
  buffer_load_dwordx4 v[76:79], v1, s[12:15], s53 offen nt
  s_waitcnt vmcnt(3)
  s_xor_b32 s53, s52, 66560
  buffer_load_dwordx4 v[80:83], v1, s[12:15], s53 offen nt
  s_waitcnt vmcnt(3)
  s_xor_b32 s53, s52, 67584
  buffer_load_dwordx4 v[84:87], v1, s[12:15], s53 offen nt
  s_waitcnt vmcnt(3)
  s_xor_b32 s53, s52, 68608
  buffer_load_dwordx4 v[88:91], v1, s[12:15], s53 offen nt
  s_waitcnt vmcnt(3)
  s_xor_b32 s53, s52, 98304
  buffer_load_dwordx4 v[92:95], v1, s[12:15], s53 offen nt
  s_waitcnt vmcnt(3)
  s_xor_b32 s53, s52, 99328
  buffer_load_dwordx4 v[96:99], v1, s[12:15], s53 offen nt
  s_waitcnt vmcnt(3)
  s_xor_b32 s53, s52, 100352
  buffer_load_dwordx4 v[100:103], v1, s[12:15], s53 offen nt
  s_waitcnt vmcnt(3)
  s_xor_b32 s53, s52, 101376
  buffer_load_dwordx4 v[104:107], v1, s[12:15], s53 offen nt
  s_waitcnt vmcnt(3)
  s_xor_b32 s53, s52, 131072
  buffer_load_dwordx4 v[108:111], v1, s[12:15], s53 offen nt
  s_waitcnt vmcnt(3)
  s_xor_b32 s53, s52, 132096
  buffer_load_dwordx4 v[112:115], v1, s[12:15], s53 offen nt
  s_waitcnt vmcnt(3)
  s_xor_b32 s53, s52, 133120
  buffer_load_dwordx4 v[116:119], v1, s[12:15], s53 offen nt
  s_waitcnt vmcnt(3)
  s_xor_b32 s53, s52, 134144
  buffer_load_dwordx4 v[120:123], v1, s[12:15], s53 offen nt
  s_waitcnt vmcnt(3)
  s_xor_b32 s53, s52, 163840
  buffer_load_dwordx4 v[124:127], v1, s[12:15], s53 offen nt
  s_waitcnt vmcnt(3)
  s_xor_b32 s53, s52, 164864
  buffer_load_dwordx4 v[128:131], v1, s[12:15], s53 offen nt
  s_waitcnt vmcnt(3)
  s_xor_b32 s53, s52, 165888
  buffer_load_dwordx4 v[132:135], v1, s[12:15], s53 offen nt
  s_waitcnt vmcnt(3)
  s_xor_b32 s53, s52, 166912
  buffer_load_dwordx4 v[136:139], v1, s[12:15], s53 offen nt
  s_mov_b32 s75, 1000000
L_wqr:
  ds_read_b128 v[8:11], v12
  s_sub_u32 s75, s75, 1
  s_cbranch_scc1 L_wqr_ok
  s_waitcnt lgkmcnt(0)
  v_max3_u32 v13, v8, v9, v10
  v_max_u32 v13, v13, v11
  v_cmp_eq_u32 vcc, -1, v13
  s_cbranch_vccnz L_wqr
L_wqr_ok:
  s_waitcnt lgkmcnt(0)
  s_and_b32 s29, s28, 0x7f7f7f7f
  s_add_u32 s29, s29, 0x07050301
  s_and_b32 s30, s28, 0x80808080
  s_xor_b32 s29, s29, s30
  s_bfe_u32 s60, s29, 0x80000
  s_bfe_u32 s61, s29, 0x80008
  s_bfe_u32 s62, s29, 0x80010
  s_bfe_u32 s63, s29, 0x80018
  s_mov_b32 s31, 0xffffff00
  s_waitcnt vmcnt(3)
  s_xor_b32 s53, s52, 196608
  buffer_load_dwordx4 v[140:143], v1, s[12:15], s53 offen nt
  v_mov_b32 v24, 0
  v_mov_b32 v25, 0
  v_mov_b32 v26, 0
  v_mov_b32 v27, 0
  v_mov_b32 v28, 0
  v_mov_b32 v29, 0
  v_mov_b32 v30, 0
  v_mov_b32 v31, 0
  v_mov_b32 v32, 0
  v_mov_b32 v33, 0
  v_mov_b32 v34, 0
  v_mov_b32 v35, 0
  v_mov_b32 v36, 0
  v_mov_b32 v37, 0
  v_mov_b32 v38, 0
  v_mov_b32 v39, 0
  v_dot2c_f32_bf16 v24, v44, v8
  v_dot2c_f32_bf16 v24, v45, v9
  v_dot2c_f32_bf16 v24, v46, v10
  v_dot2c_f32_bf16 v24, v47, v11
  v_dot2c_f32_bf16 v25, v48, v8
  v_dot2c_f32_bf16 v25, v49, v9
  v_dot2c_f32_bf16 v25, v50, v10
  v_dot2c_f32_bf16 v25, v51, v11
  v_dot2c_f32_bf16 v26, v52, v8
  v_dot2c_f32_bf16 v26, v53, v9
  v_dot2c_f32_bf16 v26, v54, v10
  v_dot2c_f32_bf16 v26, v55, v11
  v_dot2c_f32_bf16 v27, v56, v8
  v_dot2c_f32_bf16 v27, v57, v9
  v_dot2c_f32_bf16 v27, v58, v10
  v_dot2c_f32_bf16 v27, v59, v11
  s_waitcnt vmcnt(3)
  s_xor_b32 s53, s52, 197632
  buffer_load_dwordx4 v[144:147], v1, s[12:15], s53 offen nt
  v_dot2c_f32_bf16 v28, v60, v8
  v_dot2c_f32_bf16 v28, v61, v9
  v_dot2c_f32_bf16 v28, v62, v10
  v_dot2c_f32_bf16 v28, v63, v11
  v_dot2c_f32_bf16 v29, v64, v8
  v_dot2c_f32_bf16 v29, v65, v9
  v_dot2c_f32_bf16 v29, v66, v10
  v_dot2c_f32_bf16 v29, v67, v11
  v_dot2c_f32_bf16 v30, v68, v8
  v_dot2c_f32_bf16 v30, v69, v9
  v_dot2c_f32_bf16 v30, v70, v10
  v_dot2c_f32_bf16 v30, v71, v11
  v_dot2c_f32_bf16 v31, v72, v8
  v_dot2c_f32_bf16 v31, v73, v9
  v_dot2c_f32_bf16 v31, v74, v10
  v_dot2c_f32_bf16 v31, v75, v11
  s_waitcnt vmcnt(3)
  s_xor_b32 s53, s52, 198656
  buffer_load_dwordx4 v[148:151], v1, s[12:15], s53 offen nt
  v_dot2c_f32_bf16 v32, v76, v8
  v_dot2c_f32_bf16 v32, v77, v9
  v_dot2c_f32_bf16 v32, v78, v10
  v_dot2c_f32_bf16 v32, v79, v11
  v_dot2c_f32_bf16 v33, v80, v8
  v_dot2c_f32_bf16 v33, v81, v9
  v_dot2c_f32_bf16 v33, v82, v10
  v_dot2c_f32_bf16 v33, v83, v11
  v_dot2c_f32_bf16 v34, v84, v8
  v_dot2c_f32_bf16 v34, v85, v9
  v_dot2c_f32_bf16 v34, v86, v10
  v_dot2c_f32_bf16 v34, v87, v11
  v_dot2c_f32_bf16 v35, v88, v8
  v_dot2c_f32_bf16 v35, v89, v9
  v_dot2c_f32_bf16 v35, v90, v10
  v_dot2c_f32_bf16 v35, v91, v11
  s_waitcnt vmcnt(3)
  s_xor_b32 s53, s52, 199680
  buffer_load_dwordx4 v[152:155], v1, s[12:15], s53 offen nt
  v_dot2c_f32_bf16 v36, v92, v8
  v_dot2c_f32_bf16 v36, v93, v9
  v_dot2c_f32_bf16 v36, v94, v10
  v_dot2c_f32_bf16 v36, v95, v11
  v_dot2c_f32_bf16 v37, v96, v8
  v_dot2c_f32_bf16 v37, v97, v9
  v_dot2c_f32_bf16 v37, v98, v10
  v_dot2c_f32_bf16 v37, v99, v11
  v_dot2c_f32_bf16 v38, v100, v8
  v_dot2c_f32_bf16 v38, v101, v9
  v_dot2c_f32_bf16 v38, v102, v10
  v_dot2c_f32_bf16 v38, v103, v11
  s_xor_b32 s53, s52, 229376
  buffer_load_dwordx4 v[156:159], v1, s[12:15], s53 offen nt
  v_dot2c_f32_bf16 v39, v104, v8
  v_dot2c_f32_bf16 v39, v105, v9
  v_dot2c_f32_bf16 v39, v106, v10
  v_dot2c_f32_bf16 v39, v107, v11
  v_add_f32_dpp v24, v24, v24 row_ror:8 row_mask:0xf bank_mask:0x3
  v_add_f32_dpp v25, v25, v25 row_ror:8 row_mask:0xf bank_mask:0x3
  v_add_f32_dpp v26, v26, v26 row_ror:8 row_mask:0xf bank_mask:0x3
  v_add_f32_dpp v27, v27, v27 row_ror:8 row_mask:0xf bank_mask:0x3
  v_add_f32_dpp v28, v28, v28 row_ror:8 row_mask:0xf bank_mask:0x3
  v_add_f32_dpp v29, v29, v29 row_ror:8 row_mask:0xf bank_mask:0x3
  v_add_f32_dpp v30, v30, v30 row_ror:8 row_mask:0xf bank_mask:0x3
  v_add_f32_dpp v31, v31, v31 row_ror:8 row_mask:0xf bank_mask:0x3
  v_add_f32_dpp v24, v32, v32 row_ror:8 row_mask:0xf bank_mask:0xc
  v_add_f32_dpp v25, v33, v33 row_ror:8 row_mask:0xf bank_mask:0xc
  v_add_f32_dpp v26, v34, v34 row_ror:8 row_mask:0xf bank_mask:0xc
  v_add_f32_dpp v27, v35, v35 row_ror:8 row_mask:0xf bank_mask:0xc
  v_add_f32_dpp v28, v36, v36 row_ror:8 row_mask:0xf bank_mask:0xc
  v_add_f32_dpp v29, v37, v37 row_ror:8 row_mask:0xf bank_mask:0xc
  v_add_f32_dpp v30, v38, v38 row_ror:8 row_mask:0xf bank_mask:0xc
  v_add_f32_dpp v31, v39, v39 row_ror:8 row_mask:0xf bank_mask:0xc
  v_add_f32_dpp v24, v24, v24 row_half_mirror row_mask:0xf bank_mask:0x5
  v_add_f32_dpp v25, v25, v25 row_half_mirror row_mask:0xf bank_mask:0x5
  v_add_f32_dpp v26, v26, v26 row_half_mirror row_mask:0xf bank_mask:0x5
  v_add_f32_dpp v27, v27, v27 row_half_mirror row_mask:0xf bank_mask:0x5
  v_add_f32_dpp v24, v28, v28 row_half_mirror row_mask:0xf bank_mask:0xa
  v_add_f32_dpp v25, v29, v29 row_half_mirror row_mask:0xf bank_mask:0xa
  v_add_f32_dpp v26, v30, v30 row_half_mirror row_mask:0xf bank_mask:0xa
  v_add_f32_dpp v27, v31, v31 row_half_mirror row_mask:0xf bank_mask:0xa
  v_add_f32_dpp v24, v24, v24 quad_perm:[2,3,0,1] row_mask:0xf bank_mask:0xf
  v_add_f32_dpp v25, v25, v25 quad_perm:[2,3,0,1] row_mask:0xf bank_mask:0xf
  v_add_f32_dpp v26, v26, v26 quad_perm:[2,3,0,1] row_mask:0xf bank_mask:0xf
  v_add_f32_dpp v27, v27, v27 quad_perm:[2,3,0,1] row_mask:0xf bank_mask:0xf
  v_cndmask_b32 v24, v24, v26, s[64:65]
  v_cndmask_b32 v25, v25, v27, s[64:65]
  s_nop 0
  v_add_f32_dpp v24, v24, v24 quad_perm:[1,0,3,2] row_mask:0xf bank_mask:0xf
  v_add_f32_dpp v25, v25, v25 quad_perm:[1,0,3,2] row_mask:0xf bank_mask:0xf
  v_cndmask_b32 v2, v24, v25, s[66:67]
  v_cvt_pk_bf16_f32 v2, v2, v2
  v_lshlrev_b32 v2, 16, v2
  v_mul_f32 v2, 0x3db504f3, v2
  v_cvt_pk_bf16_f32 v2, v2, v2
  v_lshlrev_b32 v2, 16, v2
  s_waitcnt vmcnt(4)
  v_mov_b32 v24, 0
  v_mov_b32 v25, 0
  v_mov_b32 v26, 0
  v_mov_b32 v27, 0
  v_mov_b32 v28, 0
  v_mov_b32 v29, 0
  v_mov_b32 v30, 0
  v_mov_b32 v31, 0
  v_mov_b32 v32, 0
  v_mov_b32 v33, 0
  v_mov_b32 v34, 0
  v_mov_b32 v35, 0
  v_mov_b32 v36, 0
  v_mov_b32 v37, 0
  v_mov_b32 v38, 0
  v_mov_b32 v39, 0
  v_dot2c_f32_bf16 v24, v108, v8
  v_dot2c_f32_bf16 v24, v109, v9
  v_dot2c_f32_bf16 v24, v110, v10
  v_dot2c_f32_bf16 v24, v111, v11
  v_dot2c_f32_bf16 v25, v112, v8
  v_dot2c_f32_bf16 v25, v113, v9
  v_dot2c_f32_bf16 v25, v114, v10
  v_dot2c_f32_bf16 v25, v115, v11
  v_dot2c_f32_bf16 v26, v116, v8
  v_dot2c_f32_bf16 v26, v117, v9
  v_dot2c_f32_bf16 v26, v118, v10
  v_dot2c_f32_bf16 v26, v119, v11
  v_dot2c_f32_bf16 v27, v120, v8
  v_dot2c_f32_bf16 v27, v121, v9
  v_dot2c_f32_bf16 v27, v122, v10
  v_dot2c_f32_bf16 v27, v123, v11
  s_waitcnt vmcnt(3)
  s_xor_b32 s53, s52, 230400
  buffer_load_dwordx4 v[160:163], v1, s[12:15], s53 offen nt
  v_dot2c_f32_bf16 v28, v124, v8
  v_dot2c_f32_bf16 v28, v125, v9
  v_dot2c_f32_bf16 v28, v126, v10
  v_dot2c_f32_bf16 v28, v127, v11
  v_dot2c_f32_bf16 v29, v128, v8
  v_dot2c_f32_bf16 v29, v129, v9
  v_dot2c_f32_bf16 v29, v130, v10
  v_dot2c_f32_bf16 v29, v131, v11
  v_dot2c_f32_bf16 v30, v132, v8
  v_dot2c_f32_bf16 v30, v133, v9
  v_dot2c_f32_bf16 v30, v134, v10
  v_dot2c_f32_bf16 v30, v135, v11
  v_dot2c_f32_bf16 v31, v136, v8
  v_dot2c_f32_bf16 v31, v137, v9
  v_dot2c_f32_bf16 v31, v138, v10
  v_dot2c_f32_bf16 v31, v139, v11
  s_waitcnt vmcnt(3)
  s_xor_b32 s53, s52, 231424
  buffer_load_dwordx4 v[164:167], v1, s[12:15], s53 offen nt
  v_dot2c_f32_bf16 v32, v140, v8
  v_dot2c_f32_bf16 v32, v141, v9
  v_dot2c_f32_bf16 v32, v142, v10
  v_dot2c_f32_bf16 v32, v143, v11
  v_dot2c_f32_bf16 v33, v144, v8
  v_dot2c_f32_bf16 v33, v145, v9
  v_dot2c_f32_bf16 v33, v146, v10
  v_dot2c_f32_bf16 v33, v147, v11
  v_dot2c_f32_bf16 v34, v148, v8
  v_dot2c_f32_bf16 v34, v149, v9
  v_dot2c_f32_bf16 v34, v150, v10
  v_dot2c_f32_bf16 v34, v151, v11
  s_waitcnt vmcnt(3)
  s_xor_b32 s53, s52, 232448
  buffer_load_dwordx4 v[44:47], v1, s[12:15], s53 offen nt
  v_dot2c_f32_bf16 v35, v152, v8
  v_dot2c_f32_bf16 v35, v153, v9
  v_dot2c_f32_bf16 v35, v154, v10
  v_dot2c_f32_bf16 v35, v155, v11
  s_waitcnt vmcnt(3)
  buffer_load_dwordx4 v[48:51], v1, s[16:19], s52 offen nt
  v_dot2c_f32_bf16 v36, v156, v8
  v_dot2c_f32_bf16 v36, v157, v9
  v_dot2c_f32_bf16 v36, v158, v10
  v_dot2c_f32_bf16 v36, v159, v11
  s_waitcnt vmcnt(3)
  s_xor_b32 s53, s52, 1024
  buffer_load_dwordx4 v[52:55], v1, s[16:19], s53 offen nt
  v_dot2c_f32_bf16 v37, v160, v8
  v_dot2c_f32_bf16 v37, v161, v9
  v_dot2c_f32_bf16 v37, v162, v10
  v_dot2c_f32_bf16 v37, v163, v11
  s_waitcnt vmcnt(3)
  s_xor_b32 s53, s52, 2048
  buffer_load_dwordx4 v[56:59], v1, s[16:19], s53 offen nt
  v_dot2c_f32_bf16 v38, v164, v8
  v_dot2c_f32_bf16 v38, v165, v9
  v_dot2c_f32_bf16 v38, v166, v10
  v_dot2c_f32_bf16 v38, v167, v11
  s_waitcnt vmcnt(3)
  s_xor_b32 s53, s52, 3072
  buffer_load_dwordx4 v[60:63], v1, s[16:19], s53 offen nt
  s_xor_b32 s53, s52, 32768
  buffer_load_dwordx4 v[64:67], v1, s[16:19], s53 offen nt
  v_dot2c_f32_bf16 v39, v44, v8
  v_dot2c_f32_bf16 v39, v45, v9
  v_dot2c_f32_bf16 v39, v46, v10
  v_dot2c_f32_bf16 v39, v47, v11
  v_add_f32_dpp v24, v24, v24 row_ror:8 row_mask:0xf bank_mask:0x3
  v_add_f32_dpp v25, v25, v25 row_ror:8 row_mask:0xf bank_mask:0x3
  v_add_f32_dpp v26, v26, v26 row_ror:8 row_mask:0xf bank_mask:0x3
  v_add_f32_dpp v27, v27, v27 row_ror:8 row_mask:0xf bank_mask:0x3
  v_add_f32_dpp v28, v28, v28 row_ror:8 row_mask:0xf bank_mask:0x3
  v_add_f32_dpp v29, v29, v29 row_ror:8 row_mask:0xf bank_mask:0x3
  v_add_f32_dpp v30, v30, v30 row_ror:8 row_mask:0xf bank_mask:0x3
  v_add_f32_dpp v31, v31, v31 row_ror:8 row_mask:0xf bank_mask:0x3
  v_add_f32_dpp v24, v32, v32 row_ror:8 row_mask:0xf bank_mask:0xc
  v_add_f32_dpp v25, v33, v33 row_ror:8 row_mask:0xf bank_mask:0xc
  v_add_f32_dpp v26, v34, v34 row_ror:8 row_mask:0xf bank_mask:0xc
  v_add_f32_dpp v27, v35, v35 row_ror:8 row_mask:0xf bank_mask:0xc
  v_add_f32_dpp v28, v36, v36 row_ror:8 row_mask:0xf bank_mask:0xc
  v_add_f32_dpp v29, v37, v37 row_ror:8 row_mask:0xf bank_mask:0xc
  v_add_f32_dpp v30, v38, v38 row_ror:8 row_mask:0xf bank_mask:0xc
  v_add_f32_dpp v31, v39, v39 row_ror:8 row_mask:0xf bank_mask:0xc
  v_add_f32_dpp v24, v24, v24 row_half_mirror row_mask:0xf bank_mask:0x5
  v_add_f32_dpp v25, v25, v25 row_half_mirror row_mask:0xf bank_mask:0x5
  v_add_f32_dpp v26, v26, v26 row_half_mirror row_mask:0xf bank_mask:0x5
  v_add_f32_dpp v27, v27, v27 row_half_mirror row_mask:0xf bank_mask:0x5
  v_add_f32_dpp v24, v28, v28 row_half_mirror row_mask:0xf bank_mask:0xa
  v_add_f32_dpp v25, v29, v29 row_half_mirror row_mask:0xf bank_mask:0xa
  v_add_f32_dpp v26, v30, v30 row_half_mirror row_mask:0xf bank_mask:0xa
  v_add_f32_dpp v27, v31, v31 row_half_mirror row_mask:0xf bank_mask:0xa
  v_add_f32_dpp v24, v24, v24 quad_perm:[2,3,0,1] row_mask:0xf bank_mask:0xf
  v_add_f32_dpp v25, v25, v25 quad_perm:[2,3,0,1] row_mask:0xf bank_mask:0xf
  v_add_f32_dpp v26, v26, v26 quad_perm:[2,3,0,1] row_mask:0xf bank_mask:0xf
  v_add_f32_dpp v27, v27, v27 quad_perm:[2,3,0,1] row_mask:0xf bank_mask:0xf
  v_cndmask_b32 v24, v24, v26, s[64:65]
  v_cndmask_b32 v25, v25, v27, s[64:65]
  s_nop 0
  v_add_f32_dpp v24, v24, v24 quad_perm:[1,0,3,2] row_mask:0xf bank_mask:0xf
  v_add_f32_dpp v25, v25, v25 quad_perm:[1,0,3,2] row_mask:0xf bank_mask:0xf
  v_cndmask_b32 v3, v24, v25, s[66:67]
  v_cvt_pk_bf16_f32 v3, v3, v3
  v_lshlrev_b32 v3, 16, v3
  v_mul_f32 v3, 0x3db504f3, v3
  v_cvt_pk_bf16_f32 v3, v3, v3
  v_lshlrev_b32 v3, 16, v3
  v_max_f32 v24, v2, v3
  s_nop 1
  v_max_f32_dpp v24, v24, v24 row_shr:1 row_mask:0xf bank_mask:0xf
  s_nop 1
  v_max_f32_dpp v24, v24, v24 row_shr:2 row_mask:0xf bank_mask:0xf
  s_nop 1
  v_max_f32_dpp v24, v24, v24 row_shr:4 row_mask:0xf bank_mask:0xf
  s_nop 1
  v_max_f32_dpp v24, v24, v24 row_shr:8 row_mask:0xf bank_mask:0xf
  s_nop 1
  v_max_f32_dpp v24, v24, v24 row_bcast:15 row_mask:0xa bank_mask:0xf
  s_nop 1
  v_max_f32_dpp v24, v24, v24 row_bcast:31 row_mask:0xc bank_mask:0xf
  s_nop 0
  v_readlane_b32 s72, v24, 63
  s_nop 1
  v_subrev_f32 v2, s72, v2
  v_subrev_f32 v3, s72, v3
  v_mul_f32 v2, 0x3fb8aa3b, v2
  v_mul_f32 v3, 0x3fb8aa3b, v3
  v_exp_f32 v2, v2
  v_exp_f32 v3, v3
  s_nop 0
  v_add_f32 v25, v2, v3
  v_cvt_pk_bf16_f32 v2, v2, v2
  v_cvt_pk_bf16_f32 v3, v3, v3
  v_add_f32_dpp v25, v25, v25 row_shr:1 row_mask:0xf bank_mask:0xf
  s_nop 1
  v_add_f32_dpp v25, v25, v25 row_shr:2 row_mask:0xf bank_mask:0xf
  s_nop 1
  v_add_f32_dpp v25, v25, v25 row_shr:4 row_mask:0xf bank_mask:0xf
  s_nop 1
  v_add_f32_dpp v25, v25, v25 row_shr:8 row_mask:0xf bank_mask:0xf
  s_nop 1
  v_add_f32_dpp v25, v25, v25 row_bcast:15 row_mask:0xa bank_mask:0xf
  s_nop 1
  v_add_f32_dpp v25, v25, v25 row_bcast:31 row_mask:0xc bank_mask:0xf
  s_lshl_b32 s73, s3, 3
  s_add_u32 s73, s73, 106752
  v_mov_b32 v26, s73
  s_mov_b32 exec_lo, 0
  s_mov_b32 exec_hi, 0x80000000
  ds_write_b64 v26, v[24:25]
  s_mov_b64 exec, -1
  s_lshl_b32 s73, s3, 9
  s_add_u32 s73, s73, 100352
  v_and_b32 v27, 15, v0
  v_lshrrev_b32 v28, 4, v0
  v_lshlrev_b32 v29, 5, v27
  v_lshl_add_u32 v29, v28, 4, v29
  v_add_u32 v29, s73, v29
  v_and_b32_dpp v12, v2, v4 row_newbcast:0 row_mask:0xf bank_mask:0xf
  v_and_b32_dpp v13, v2, v5 row_newbcast:0 row_mask:0xf bank_mask:0xf
  v_and_b32_dpp v14, v2, v6 row_newbcast:0 row_mask:0xf bank_mask:0xf
  v_and_b32_dpp v15, v2, v7 row_newbcast:0 row_mask:0xf bank_mask:0xf
  s_waitcnt vmcnt(4)
  s_nop 0
  v_mfma_f32_16x16x32_bf16 v[20:23], v[12:15], v[48:51], 0
  v_and_b32_dpp v16, v2, v4 row_newbcast:1 row_mask:0xf bank_mask:0xf
  v_and_b32_dpp v17, v2, v5 row_newbcast:1 row_mask:0xf bank_mask:0xf
  v_and_b32_dpp v18, v2, v6 row_newbcast:1 row_mask:0xf bank_mask:0xf
  v_and_b32_dpp v19, v2, v7 row_newbcast:1 row_mask:0xf bank_mask:0xf
  s_waitcnt vmcnt(3)
  s_xor_b32 s53, s52, 33792
  buffer_load_dwordx4 v[68:71], v1, s[16:19], s53 offen nt
  v_mfma_f32_16x16x32_bf16 v[20:23], v[16:19], v[52:55], v[20:23]
  v_and_b32_dpp v12, v2, v4 row_newbcast:2 row_mask:0xf bank_mask:0xf
  v_and_b32_dpp v13, v2, v5 row_newbcast:2 row_mask:0xf bank_mask:0xf
  v_and_b32_dpp v14, v2, v6 row_newbcast:2 row_mask:0xf bank_mask:0xf
  v_and_b32_dpp v15, v2, v7 row_newbcast:2 row_mask:0xf bank_mask:0xf
  s_waitcnt vmcnt(3)
  s_xor_b32 s53, s52, 34816
  buffer_load_dwordx4 v[72:75], v1, s[16:19], s53 offen nt
  v_mfma_f32_16x16x32_bf16 v[20:23], v[12:15], v[56:59], v[20:23]
  v_and_b32_dpp v16, v2, v4 row_newbcast:3 row_mask:0xf bank_mask:0xf
  v_and_b32_dpp v17, v2, v5 row_newbcast:3 row_mask:0xf bank_mask:0xf
  v_and_b32_dpp v18, v2, v6 row_newbcast:3 row_mask:0xf bank_mask:0xf
  v_and_b32_dpp v19, v2, v7 row_newbcast:3 row_mask:0xf bank_mask:0xf
  s_waitcnt vmcnt(3)
  s_xor_b32 s53, s52, 35840
  buffer_load_dwordx4 v[76:79], v1, s[16:19], s53 offen nt
  v_mfma_f32_16x16x32_bf16 v[20:23], v[16:19], v[60:63], v[20:23]
  v_and_b32_dpp v12, v2, v4 row_newbcast:4 row_mask:0xf bank_mask:0xf
  v_and_b32_dpp v13, v2, v5 row_newbcast:4 row_mask:0xf bank_mask:0xf
  v_and_b32_dpp v14, v2, v6 row_newbcast:4 row_mask:0xf bank_mask:0xf
  v_and_b32_dpp v15, v2, v7 row_newbcast:4 row_mask:0xf bank_mask:0xf
  s_waitcnt vmcnt(3)
  s_xor_b32 s53, s52, 65536
  buffer_load_dwordx4 v[80:83], v1, s[16:19], s53 offen nt
  v_mfma_f32_16x16x32_bf16 v[20:23], v[12:15], v[64:67], v[20:23]
  v_and_b32_dpp v16, v2, v4 row_newbcast:5 row_mask:0xf bank_mask:0xf
  v_and_b32_dpp v17, v2, v5 row_newbcast:5 row_mask:0xf bank_mask:0xf
  v_and_b32_dpp v18, v2, v6 row_newbcast:5 row_mask:0xf bank_mask:0xf
  v_and_b32_dpp v19, v2, v7 row_newbcast:5 row_mask:0xf bank_mask:0xf
  s_waitcnt vmcnt(3)
  s_xor_b32 s53, s52, 66560
  buffer_load_dwordx4 v[84:87], v1, s[16:19], s53 offen nt
  v_mfma_f32_16x16x32_bf16 v[20:23], v[16:19], v[68:71], v[20:23]
  v_and_b32_dpp v12, v2, v4 row_newbcast:6 row_mask:0xf bank_mask:0xf
  v_and_b32_dpp v13, v2, v5 row_newbcast:6 row_mask:0xf bank_mask:0xf
  v_and_b32_dpp v14, v2, v6 row_newbcast:6 row_mask:0xf bank_mask:0xf
  v_and_b32_dpp v15, v2, v7 row_newbcast:6 row_mask:0xf bank_mask:0xf
  s_waitcnt vmcnt(3)
  s_xor_b32 s53, s52, 67584
  buffer_load_dwordx4 v[88:91], v1, s[16:19], s53 offen nt
  v_mfma_f32_16x16x32_bf16 v[20:23], v[12:15], v[72:75], v[20:23]
  v_and_b32_dpp v16, v2, v4 row_newbcast:7 row_mask:0xf bank_mask:0xf
  v_and_b32_dpp v17, v2, v5 row_newbcast:7 row_mask:0xf bank_mask:0xf
  v_and_b32_dpp v18, v2, v6 row_newbcast:7 row_mask:0xf bank_mask:0xf
  v_and_b32_dpp v19, v2, v7 row_newbcast:7 row_mask:0xf bank_mask:0xf
  s_waitcnt vmcnt(3)
  s_xor_b32 s53, s52, 68608
  buffer_load_dwordx4 v[92:95], v1, s[16:19], s53 offen nt
  v_mfma_f32_16x16x32_bf16 v[20:23], v[16:19], v[76:79], v[20:23]
  v_and_b32_dpp v12, v2, v4 row_newbcast:8 row_mask:0xf bank_mask:0xf
  v_and_b32_dpp v13, v2, v5 row_newbcast:8 row_mask:0xf bank_mask:0xf
  v_and_b32_dpp v14, v2, v6 row_newbcast:8 row_mask:0xf bank_mask:0xf
  v_and_b32_dpp v15, v2, v7 row_newbcast:8 row_mask:0xf bank_mask:0xf
  s_waitcnt vmcnt(3)
  s_xor_b32 s53, s52, 98304
  buffer_load_dwordx4 v[96:99], v1, s[16:19], s53 offen nt
  v_mfma_f32_16x16x32_bf16 v[20:23], v[12:15], v[80:83], v[20:23]
  v_and_b32_dpp v16, v2, v4 row_newbcast:9 row_mask:0xf bank_mask:0xf
  v_and_b32_dpp v17, v2, v5 row_newbcast:9 row_mask:0xf bank_mask:0xf
  v_and_b32_dpp v18, v2, v6 row_newbcast:9 row_mask:0xf bank_mask:0xf
  v_and_b32_dpp v19, v2, v7 row_newbcast:9 row_mask:0xf bank_mask:0xf
  s_waitcnt vmcnt(3)
  s_xor_b32 s53, s52, 99328
  buffer_load_dwordx4 v[100:103], v1, s[16:19], s53 offen nt
  v_mfma_f32_16x16x32_bf16 v[20:23], v[16:19], v[84:87], v[20:23]
  v_and_b32_dpp v12, v2, v4 row_newbcast:10 row_mask:0xf bank_mask:0xf
  v_and_b32_dpp v13, v2, v5 row_newbcast:10 row_mask:0xf bank_mask:0xf
  v_and_b32_dpp v14, v2, v6 row_newbcast:10 row_mask:0xf bank_mask:0xf
  v_and_b32_dpp v15, v2, v7 row_newbcast:10 row_mask:0xf bank_mask:0xf
  s_waitcnt vmcnt(3)
  s_xor_b32 s53, s52, 100352
  buffer_load_dwordx4 v[104:107], v1, s[16:19], s53 offen nt
  v_mfma_f32_16x16x32_bf16 v[20:23], v[12:15], v[88:91], v[20:23]
  v_and_b32_dpp v16, v2, v4 row_newbcast:11 row_mask:0xf bank_mask:0xf
  v_and_b32_dpp v17, v2, v5 row_newbcast:11 row_mask:0xf bank_mask:0xf
  v_and_b32_dpp v18, v2, v6 row_newbcast:11 row_mask:0xf bank_mask:0xf
  v_and_b32_dpp v19, v2, v7 row_newbcast:11 row_mask:0xf bank_mask:0xf
  s_waitcnt vmcnt(3)
  s_xor_b32 s53, s52, 101376
  buffer_load_dwordx4 v[108:111], v1, s[16:19], s53 offen nt
  v_mfma_f32_16x16x32_bf16 v[20:23], v[16:19], v[92:95], v[20:23]
  v_and_b32_dpp v12, v2, v4 row_newbcast:12 row_mask:0xf bank_mask:0xf
  v_and_b32_dpp v13, v2, v5 row_newbcast:12 row_mask:0xf bank_mask:0xf
  v_and_b32_dpp v14, v2, v6 row_newbcast:12 row_mask:0xf bank_mask:0xf
  v_and_b32_dpp v15, v2, v7 row_newbcast:12 row_mask:0xf bank_mask:0xf
  s_waitcnt vmcnt(3)
  s_xor_b32 s53, s52, 131072
  buffer_load_dwordx4 v[112:115], v1, s[16:19], s53 offen nt
  v_mfma_f32_16x16x32_bf16 v[20:23], v[12:15], v[96:99], v[20:23]
  s_and_b32 s76, s2, 7
  s_lshr_b32 s77, s3, 1
  s_lshl_b32 s78, s77, 3
  s_add_u32 s78, s78, s76
  s_lshl_b32 s68, s78, 17
  s_lshl_b32 s78, s78, 1
  s_and_b32 s73, s3, 1
  s_add_u32 s78, s78, s73
  s_lshl_b32 s79, s78, 9
  s_add_u32 s79, s79, 4096
  s_lshl_b32 s78, s78, 11
  s_add_u32 s78, s78, 36864
  s_lshl_b32 s69, s73, 16
  s_add_u32 s68, s68, s69
  s_bfe_u32 s69, s2, 0x30003
  s_lshl_b32 s69, s69, 7
  s_add_u32 s68, s68, s69
  s_lshl_b32 s69, s3, 13
  v_and_b32 v31, 3, v0
  v_lshlrev_b32 v31, 7, v31
  s_mul_i32 s73, s73, 1088
  s_lshl_b32 s77, s77, 8
  s_add_u32 s73, s73, s77
  s_add_u32 s73, s73, 107776
  v_and_b32 v30, 31, v0
  v_lshlrev_b32 v30, 3, v30
  v_lshrrev_b32 v32, 5, v0
  v_lshl_add_u32 v30, v32, 2, v30
  v_add_u32 v30, s73, v30
  s_getreg_b32 s74, hwreg(HW_REG_XCC_ID, 0, 4)
  v_lshrrev_b32 v32, 3, v0
  v_and_b32 v33, 7, v0
  v_lshlrev_b32 v32, 10, v32
  v_lshl_or_b32 v32, v33, 4, v32
  v_and_b32_dpp v16, v2, v4 row_newbcast:13 row_mask:0xf bank_mask:0xf
  v_and_b32_dpp v17, v2, v5 row_newbcast:13 row_mask:0xf bank_mask:0xf
  v_and_b32_dpp v18, v2, v6 row_newbcast:13 row_mask:0xf bank_mask:0xf
  v_and_b32_dpp v19, v2, v7 row_newbcast:13 row_mask:0xf bank_mask:0xf
  s_waitcnt vmcnt(3)
  s_xor_b32 s53, s52, 132096
  buffer_load_dwordx4 v[116:119], v1, s[16:19], s53 offen nt
  v_mfma_f32_16x16x32_bf16 v[20:23], v[16:19], v[100:103], v[20:23]
  v_and_b32_dpp v12, v2, v4 row_newbcast:14 row_mask:0xf bank_mask:0xf
  v_and_b32_dpp v13, v2, v5 row_newbcast:14 row_mask:0xf bank_mask:0xf
  v_and_b32_dpp v14, v2, v6 row_newbcast:14 row_mask:0xf bank_mask:0xf
  v_and_b32_dpp v15, v2, v7 row_newbcast:14 row_mask:0xf bank_mask:0xf
  s_waitcnt vmcnt(3)
  s_xor_b32 s53, s52, 133120
  buffer_load_dwordx4 v[120:123], v1, s[16:19], s53 offen nt
  v_mfma_f32_16x16x32_bf16 v[20:23], v[12:15], v[104:107], v[20:23]
  v_and_b32_dpp v16, v2, v4 row_newbcast:15 row_mask:0xf bank_mask:0xf
  v_and_b32_dpp v17, v2, v5 row_newbcast:15 row_mask:0xf bank_mask:0xf
  v_and_b32_dpp v18, v2, v6 row_newbcast:15 row_mask:0xf bank_mask:0xf
  v_and_b32_dpp v19, v2, v7 row_newbcast:15 row_mask:0xf bank_mask:0xf
  s_waitcnt vmcnt(3)
  s_xor_b32 s53, s52, 134144
  buffer_load_dwordx4 v[124:127], v1, s[16:19], s53 offen nt
  v_mfma_f32_16x16x32_bf16 v[20:23], v[16:19], v[108:111], v[20:23]
  v_and_b32_dpp v12, v3, v4 row_newbcast:0 row_mask:0xf bank_mask:0xf
  v_and_b32_dpp v13, v3, v5 row_newbcast:0 row_mask:0xf bank_mask:0xf
  v_and_b32_dpp v14, v3, v6 row_newbcast:0 row_mask:0xf bank_mask:0xf
  v_and_b32_dpp v15, v3, v7 row_newbcast:0 row_mask:0xf bank_mask:0xf
  s_waitcnt vmcnt(3)
  s_xor_b32 s53, s52, 163840
  buffer_load_dwordx4 v[128:131], v1, s[16:19], s53 offen nt
  v_mfma_f32_16x16x32_bf16 v[20:23], v[12:15], v[112:115], v[20:23]
  v_and_b32_dpp v16, v3, v4 row_newbcast:1 row_mask:0xf bank_mask:0xf
  v_and_b32_dpp v17, v3, v5 row_newbcast:1 row_mask:0xf bank_mask:0xf
  v_and_b32_dpp v18, v3, v6 row_newbcast:1 row_mask:0xf bank_mask:0xf
  v_and_b32_dpp v19, v3, v7 row_newbcast:1 row_mask:0xf bank_mask:0xf
  s_waitcnt vmcnt(3)
  s_xor_b32 s53, s52, 164864
  buffer_load_dwordx4 v[132:135], v1, s[16:19], s53 offen nt
  v_mfma_f32_16x16x32_bf16 v[20:23], v[16:19], v[116:119], v[20:23]
  v_and_b32_dpp v12, v3, v4 row_newbcast:2 row_mask:0xf bank_mask:0xf
  v_and_b32_dpp v13, v3, v5 row_newbcast:2 row_mask:0xf bank_mask:0xf
  v_and_b32_dpp v14, v3, v6 row_newbcast:2 row_mask:0xf bank_mask:0xf
  v_and_b32_dpp v15, v3, v7 row_newbcast:2 row_mask:0xf bank_mask:0xf
  s_waitcnt vmcnt(3)
  s_xor_b32 s53, s52, 165888
  buffer_load_dwordx4 v[136:139], v1, s[16:19], s53 offen nt
  v_mfma_f32_16x16x32_bf16 v[20:23], v[12:15], v[120:123], v[20:23]
  v_and_b32_dpp v16, v3, v4 row_newbcast:3 row_mask:0xf bank_mask:0xf
  v_and_b32_dpp v17, v3, v5 row_newbcast:3 row_mask:0xf bank_mask:0xf
  v_and_b32_dpp v18, v3, v6 row_newbcast:3 row_mask:0xf bank_mask:0xf
  v_and_b32_dpp v19, v3, v7 row_newbcast:3 row_mask:0xf bank_mask:0xf
  s_waitcnt vmcnt(3)
  s_xor_b32 s53, s52, 166912
  buffer_load_dwordx4 v[140:143], v1, s[16:19], s53 offen nt
  v_mfma_f32_16x16x32_bf16 v[20:23], v[16:19], v[124:127], v[20:23]
  v_and_b32_dpp v12, v3, v4 row_newbcast:4 row_mask:0xf bank_mask:0xf
  v_and_b32_dpp v13, v3, v5 row_newbcast:4 row_mask:0xf bank_mask:0xf
  v_and_b32_dpp v14, v3, v6 row_newbcast:4 row_mask:0xf bank_mask:0xf
  v_and_b32_dpp v15, v3, v7 row_newbcast:4 row_mask:0xf bank_mask:0xf
  s_waitcnt vmcnt(3)
  s_xor_b32 s53, s52, 196608
  buffer_load_dwordx4 v[144:147], v1, s[16:19], s53 offen nt
  v_mfma_f32_16x16x32_bf16 v[20:23], v[12:15], v[128:131], v[20:23]
  buffer_load_dwordx4 v[40:43], v31, s[24:27], s79 offen sc1
  v_and_b32_dpp v16, v3, v4 row_newbcast:5 row_mask:0xf bank_mask:0xf
  v_and_b32_dpp v17, v3, v5 row_newbcast:5 row_mask:0xf bank_mask:0xf
  v_and_b32_dpp v18, v3, v6 row_newbcast:5 row_mask:0xf bank_mask:0xf
  v_and_b32_dpp v19, v3, v7 row_newbcast:5 row_mask:0xf bank_mask:0xf
  s_waitcnt vmcnt(4)
  s_xor_b32 s53, s52, 197632
  buffer_load_dwordx4 v[148:151], v1, s[16:19], s53 offen nt
  v_mfma_f32_16x16x32_bf16 v[20:23], v[16:19], v[132:135], v[20:23]
  v_and_b32_dpp v12, v3, v4 row_newbcast:6 row_mask:0xf bank_mask:0xf
  v_and_b32_dpp v13, v3, v5 row_newbcast:6 row_mask:0xf bank_mask:0xf
  v_and_b32_dpp v14, v3, v6 row_newbcast:6 row_mask:0xf bank_mask:0xf
  v_and_b32_dpp v15, v3, v7 row_newbcast:6 row_mask:0xf bank_mask:0xf
  s_waitcnt vmcnt(4)
  s_xor_b32 s53, s52, 198656
  buffer_load_dwordx4 v[152:155], v1, s[16:19], s53 offen nt
  v_mfma_f32_16x16x32_bf16 v[20:23], v[12:15], v[136:139], v[20:23]
  v_and_b32_dpp v16, v3, v4 row_newbcast:7 row_mask:0xf bank_mask:0xf
  v_and_b32_dpp v17, v3, v5 row_newbcast:7 row_mask:0xf bank_mask:0xf
  v_and_b32_dpp v18, v3, v6 row_newbcast:7 row_mask:0xf bank_mask:0xf
  v_and_b32_dpp v19, v3, v7 row_newbcast:7 row_mask:0xf bank_mask:0xf
  s_waitcnt vmcnt(4)
  s_xor_b32 s53, s52, 199680
  buffer_load_dwordx4 v[156:159], v1, s[16:19], s53 offen nt
  v_mfma_f32_16x16x32_bf16 v[20:23], v[16:19], v[140:143], v[20:23]
  v_and_b32_dpp v12, v3, v4 row_newbcast:8 row_mask:0xf bank_mask:0xf
  v_and_b32_dpp v13, v3, v5 row_newbcast:8 row_mask:0xf bank_mask:0xf
  v_and_b32_dpp v14, v3, v6 row_newbcast:8 row_mask:0xf bank_mask:0xf
  v_and_b32_dpp v15, v3, v7 row_newbcast:8 row_mask:0xf bank_mask:0xf
  s_waitcnt vmcnt(4)
  s_xor_b32 s53, s52, 229376
  buffer_load_dwordx4 v[160:163], v1, s[16:19], s53 offen nt
  v_mfma_f32_16x16x32_bf16 v[20:23], v[12:15], v[144:147], v[20:23]
  v_and_b32_dpp v16, v3, v4 row_newbcast:9 row_mask:0xf bank_mask:0xf
  v_and_b32_dpp v17, v3, v5 row_newbcast:9 row_mask:0xf bank_mask:0xf
  v_and_b32_dpp v18, v3, v6 row_newbcast:9 row_mask:0xf bank_mask:0xf
  v_and_b32_dpp v19, v3, v7 row_newbcast:9 row_mask:0xf bank_mask:0xf
  s_waitcnt vmcnt(3)
  s_xor_b32 s53, s52, 230400
  buffer_load_dwordx4 v[164:167], v1, s[16:19], s53 offen nt
  v_mfma_f32_16x16x32_bf16 v[20:23], v[16:19], v[148:151], v[20:23]
  v_and_b32_dpp v12, v3, v4 row_newbcast:10 row_mask:0xf bank_mask:0xf
  v_and_b32_dpp v13, v3, v5 row_newbcast:10 row_mask:0xf bank_mask:0xf
  v_and_b32_dpp v14, v3, v6 row_newbcast:10 row_mask:0xf bank_mask:0xf
  v_and_b32_dpp v15, v3, v7 row_newbcast:10 row_mask:0xf bank_mask:0xf
  s_waitcnt vmcnt(3)
  s_xor_b32 s53, s52, 231424
  buffer_load_dwordx4 v[44:47], v1, s[16:19], s53 offen nt
  v_mfma_f32_16x16x32_bf16 v[20:23], v[12:15], v[152:155], v[20:23]
  v_and_b32_dpp v16, v3, v4 row_newbcast:11 row_mask:0xf bank_mask:0xf
  v_and_b32_dpp v17, v3, v5 row_newbcast:11 row_mask:0xf bank_mask:0xf
  v_and_b32_dpp v18, v3, v6 row_newbcast:11 row_mask:0xf bank_mask:0xf
  v_and_b32_dpp v19, v3, v7 row_newbcast:11 row_mask:0xf bank_mask:0xf
  s_waitcnt vmcnt(3)
  s_xor_b32 s53, s52, 232448
  buffer_load_dwordx4 v[48:51], v1, s[16:19], s53 offen nt
  v_mfma_f32_16x16x32_bf16 v[20:23], v[16:19], v[156:159], v[20:23]
  v_and_b32_dpp v12, v3, v4 row_newbcast:12 row_mask:0xf bank_mask:0xf
  v_and_b32_dpp v13, v3, v5 row_newbcast:12 row_mask:0xf bank_mask:0xf
  v_and_b32_dpp v14, v3, v6 row_newbcast:12 row_mask:0xf bank_mask:0xf
  v_and_b32_dpp v15, v3, v7 row_newbcast:12 row_mask:0xf bank_mask:0xf
  s_waitcnt vmcnt(3)
  s_add_u32 m0, s69, 0
  s_add_u32 s53, s68, 0
  buffer_load_dwordx4 v32, s[20:23], s53 offen  lds
  v_mfma_f32_16x16x32_bf16 v[20:23], v[12:15], v[160:163], v[20:23]
  v_and_b32_dpp v16, v3, v4 row_newbcast:13 row_mask:0xf bank_mask:0xf
  v_and_b32_dpp v17, v3, v5 row_newbcast:13 row_mask:0xf bank_mask:0xf
  v_and_b32_dpp v18, v3, v6 row_newbcast:13 row_mask:0xf bank_mask:0xf
  v_and_b32_dpp v19, v3, v7 row_newbcast:13 row_mask:0xf bank_mask:0xf
  s_waitcnt vmcnt(3)
  s_add_u32 m0, s69, 1024
  s_add_u32 s53, s68, 8192
  buffer_load_dwordx4 v32, s[20:23], s53 offen  lds
  v_mfma_f32_16x16x32_bf16 v[20:23], v[16:19], v[164:167], v[20:23]
  v_and_b32_dpp v12, v3, v4 row_newbcast:14 row_mask:0xf bank_mask:0xf
  v_and_b32_dpp v13, v3, v5 row_newbcast:14 row_mask:0xf bank_mask:0xf
  v_and_b32_dpp v14, v3, v6 row_newbcast:14 row_mask:0xf bank_mask:0xf
  v_and_b32_dpp v15, v3, v7 row_newbcast:14 row_mask:0xf bank_mask:0xf
  s_waitcnt vmcnt(3)
  s_add_u32 m0, s69, 2048
  s_add_u32 s53, s68, 16384
  buffer_load_dwordx4 v32, s[20:23], s53 offen  lds
  v_mfma_f32_16x16x32_bf16 v[20:23], v[12:15], v[44:47], v[20:23]
  v_and_b32_dpp v16, v3, v4 row_newbcast:15 row_mask:0xf bank_mask:0xf
  v_and_b32_dpp v17, v3, v5 row_newbcast:15 row_mask:0xf bank_mask:0xf
  v_and_b32_dpp v18, v3, v6 row_newbcast:15 row_mask:0xf bank_mask:0xf
  v_and_b32_dpp v19, v3, v7 row_newbcast:15 row_mask:0xf bank_mask:0xf
  s_waitcnt vmcnt(3)
  s_nop 0
  v_mfma_f32_16x16x32_bf16 v[20:23], v[16:19], v[48:51], v[20:23]
  s_mov_b32 exec_hi, 0
  s_nop 6
  ds_write_b128 v29, v[20:23]
  s_mov_b64 exec, -1
  s_add_u32 m0, s69, 3072
  s_add_u32 s53, s68, 24576
  buffer_load_dwordx4 v32, s[20:23], s53 offen  lds
  s_add_u32 m0, s69, 4096
  s_add_u32 s53, s68, 32768
  buffer_load_dwordx4 v32, s[20:23], s53 offen  lds
  s_add_u32 m0, s69, 5120
  s_add_u32 s53, s68, 40960
  buffer_load_dwordx4 v32, s[20:23], s53 offen  lds
  s_add_u32 m0, s69, 6144
  s_add_u32 s53, s68, 49152
  buffer_load_dwordx4 v32, s[20:23], s53 offen  lds
  s_add_u32 m0, s69, 7168
  s_add_u32 s53, s68, 57344
  buffer_load_dwordx4 v32, s[20:23], s53 offen  lds
L_w_rk_0:
  s_cbranch_execz L_w_rk_1
  s_mov_b32 s75, 1000000
L_w_rk_1:
  s_cbranch_execz L_w_rk_2
  s_branch L_pL_chk
L_pL:
  buffer_load_dwordx4 v[40:43], v31, s[24:27], s79 offen sc1
  s_sub_u32 s75, s75, 1
  s_cbranch_scc1 L_pL_ok
  s_waitcnt vmcnt(0)
L_pL_chk:
  v_xor_b32 v54, s29, v42
  v_xor_b32 v55, s29, v43
  v_lshrrev_b32 v56, 4, v55
  v_or_b32 v54, v54, v56
  v_cmp_ne_u32 vcc, 0, v54
  s_cbranch_vccnz L_pL
L_pL_ok:
  v_mov_b32 v52, v40
  v_mov_b32 v53, v41
  v_mov_b32 v56, v52
L_w_rk_2:
  s_cbranch_execz L_w_rk_3
  s_nop 1
  v_max_f32_dpp v56, v56, v56 quad_perm:[1,0,3,2] row_mask:0xf bank_mask:0xf
  s_nop 1
  v_max_f32_dpp v56, v56, v56 quad_perm:[2,3,0,1] row_mask:0xf bank_mask:0xf
  v_sub_f32 v52, v52, v56
  v_mul_f32 v52, 0x3fb8aa3b, v52
  v_exp_f32 v52, v52
  s_nop 0
  v_mul_f32 v53, v53, v52
  s_nop 1
  v_add_f32_dpp v53, v53, v53 quad_perm:[1,0,3,2] row_mask:0xf bank_mask:0xf
L_w_rk_3:
  s_cbranch_execz L_w_rk_4
  s_nop 1
  v_add_f32_dpp v53, v53, v53 quad_perm:[2,3,0,1] row_mask:0xf bank_mask:0xf
  v_rcp_f32 v53, v53
  s_nop 0
  v_mul_f32 v52, v52, v53
  v_mov_b32 v54, 131072
  v_cmp_ne_u32 vcc, s74, v55
  s_nop 1
  v_cndmask_b32 v55, 0, v54, vcc
  v_mov_b32_dpp v56, v52 quad_perm:[0,0,0,0] row_mask:0x3 bank_mask:0xf
  v_mov_b32_dpp v57, v52 quad_perm:[2,2,2,2] row_mask:0x3 bank_mask:0xf
L_w_rk_4:
  s_cbranch_execz L_w_rk_5
  s_nop 0
  v_mov_b32_dpp v56, v52 quad_perm:[1,1,1,1] row_mask:0xc bank_mask:0xf
  v_mov_b32_dpp v57, v52 quad_perm:[3,3,3,3] row_mask:0xc bank_mask:0xf
  v_mov_b32_dpp v58, v55 quad_perm:[0,0,0,0] row_mask:0x3 bank_mask:0xf
  v_mov_b32_dpp v59, v55 quad_perm:[2,2,2,2] row_mask:0x3 bank_mask:0xf
  s_nop 0
  v_mov_b32_dpp v58, v55 quad_perm:[1,1,1,1] row_mask:0xc bank_mask:0xf
  v_mov_b32_dpp v59, v55 quad_perm:[3,3,3,3] row_mask:0xc bank_mask:0xf
  v_add_u32 v58, v58, v1
L_w_rk_5:
  s_cbranch_execz L_w_rk_6
  v_add_u32 v59, v59, v1
  s_lshl_b32 s73, s3, 2
  s_add_u32 s73, s73, 106816
  v_mov_b32 v26, s73
  v_mov_b32 v27, 0
  s_mov_b32 s68, 0x0c0c0400
  s_mov_b32 s69, 0x04000c0c
  s_mov_b32 s75, 1000000
L_pA:
  buffer_load_dwordx4 v[44:47], v58, s[24:27], s78 offen sc1
  buffer_load_dwordx4 v[48:51], v59, s[24:27], s78 offen offset:1024 sc1
L_w_rk_6:
  s_cbranch_execz L_w_rk_7
  s_cmp_lg_u32 s75, 999600
  s_cbranch_scc1 L_pA_nf
  v_add_u32 v58, v54, v1
  v_add_u32 v59, v54, v1
L_pA_nf:
  s_sub_u32 s75, s75, 1
  s_cbranch_scc1 L_pA_ok
  s_waitcnt vmcnt(2)
  ds_write_b32 v26, v27
  s_waitcnt vmcnt(0)
  v_xor_b32 v44, s60, v44
  v_xor_b32 v45, s61, v45
  v_xor_b32 v46, s62, v46
L_w_rk_7:
  s_cbranch_execz L_w_rk_8
  v_xor_b32 v47, s63, v47
  v_xor_b32 v48, s60, v48
  v_xor_b32 v49, s61, v49
  v_xor_b32 v50, s62, v50
  v_xor_b32 v51, s63, v51
  v_or3_b32 v60, v44, v45, v46
  v_or3_b32 v60, v60, v47, v48
  v_or3_b32 v60, v60, v49, v50
  v_or_b32 v60, v60, v51
  v_and_b32 v60, 0xff, v60
  v_cmp_ne_u32 vcc, 0, v60
L_w_rk_8:
  s_cbranch_execz L_w_rk_9
  s_cbranch_vccnz L_pA
L_pA_ok:
  v_mul_f32 v44, v44, v56
  v_mul_f32 v45, v45, v56
  v_mul_f32 v46, v46, v56
  v_mul_f32 v47, v47, v56
  v_fmac_f32 v44, v48, v57
  v_fmac_f32 v45, v49, v57
  v_fmac_f32 v46, v50, v57
  v_fmac_f32 v47, v51, v57
  s_nop 0
  v_permlane32_swap_b32 v44, v46
  v_permlane32_swap_b32 v45, v47
  v_add_f32 v44, v44, v46
  v_add_f32 v45, v45, v47
  v_cvt_pk_bf16_f32 v44, v44, v45
L_w_rk_9:
  s_cbranch_execz L_wret
  ds_write_b32 v30, v44
  s_waitcnt lgkmcnt(0)
  s_barrier
  s_mov_b64 exec, -1
  s_branch L_fin
L_kv_m:
  s_load_dwordx2 s[44:45], s[0:1], 48
  s_mov_b32 s46, 1024
  s_mov_b32 s47, 0x20000
  s_load_dwordx2 s[48:49], s[0:1], 80
  s_mov_b32 s50, 2048
  s_mov_b32 s51, 0x20000
  s_load_dwordx2 s[32:33], s[0:1], 56
  s_mov_b32 s34, 1409024
  s_mov_b32 s35, 0x20000
  s_load_dwordx2 s[36:37], s[0:1], 64
  s_mov_b32 s38, 1409024
  s_mov_b32 s39, 0x20000
  s_load_dwordx2 s[40:41], s[0:1], 72
  s_mov_b32 s42, 1409024
  s_mov_b32 s43, 0x20000
  s_xor_b32 s53, s52, 32768
  buffer_load_dwordx4 v[60:63], v1, s[12:15], s53 offen nt
  s_xor_b32 s53, s52, 33792
  buffer_load_dwordx4 v[64:67], v1, s[12:15], s53 offen nt
  s_waitcnt vmcnt(3)
  s_xor_b32 s53, s52, 34816
  buffer_load_dwordx4 v[68:71], v1, s[12:15], s53 offen nt
  s_waitcnt vmcnt(3)
  s_xor_b32 s53, s52, 35840
  buffer_load_dwordx4 v[72:75], v1, s[12:15], s53 offen nt
  s_waitcnt vmcnt(3)
  s_xor_b32 s53, s52, 65536
  buffer_load_dwordx4 v[76:79], v1, s[12:15], s53 offen nt
  s_waitcnt vmcnt(3)
  s_xor_b32 s53, s52, 66560
  buffer_load_dwordx4 v[80:83], v1, s[12:15], s53 offen nt
  s_waitcnt vmcnt(3)
  s_xor_b32 s53, s52, 67584
  buffer_load_dwordx4 v[84:87], v1, s[12:15], s53 offen nt
  s_waitcnt vmcnt(3)
  s_xor_b32 s53, s52, 68608
  buffer_load_dwordx4 v[88:91], v1, s[12:15], s53 offen nt
  s_waitcnt vmcnt(3)
  s_xor_b32 s53, s52, 98304
  buffer_load_dwordx4 v[92:95], v1, s[12:15], s53 offen nt
  s_waitcnt vmcnt(3)
  s_xor_b32 s53, s52, 99328
  buffer_load_dwordx4 v[96:99], v1, s[12:15], s53 offen nt
  s_waitcnt vmcnt(3)
  s_xor_b32 s53, s52, 100352
  buffer_load_dwordx4 v[100:103], v1, s[12:15], s53 offen nt
  s_waitcnt vmcnt(3)
  s_xor_b32 s53, s52, 101376
  buffer_load_dwordx4 v[104:107], v1, s[12:15], s53 offen nt
  s_waitcnt vmcnt(3)
  s_xor_b32 s53, s52, 131072
  buffer_load_dwordx4 v[108:111], v1, s[12:15], s53 offen nt
  s_waitcnt vmcnt(3)
  s_xor_b32 s53, s52, 132096
  buffer_load_dwordx4 v[112:115], v1, s[12:15], s53 offen nt
  s_waitcnt vmcnt(3)
  s_xor_b32 s53, s52, 133120
  buffer_load_dwordx4 v[116:119], v1, s[12:15], s53 offen nt
  s_waitcnt vmcnt(3)
  s_xor_b32 s53, s52, 134144
  buffer_load_dwordx4 v[120:123], v1, s[12:15], s53 offen nt
  s_waitcnt vmcnt(3)
  s_xor_b32 s53, s52, 163840
  buffer_load_dwordx4 v[124:127], v1, s[12:15], s53 offen nt
  s_waitcnt vmcnt(3)
  s_xor_b32 s53, s52, 164864
  buffer_load_dwordx4 v[128:131], v1, s[12:15], s53 offen nt
  s_waitcnt vmcnt(3)
  s_xor_b32 s53, s52, 165888
  buffer_load_dwordx4 v[132:135], v1, s[12:15], s53 offen nt
  s_waitcnt vmcnt(3)
  s_xor_b32 s53, s52, 166912
  buffer_load_dwordx4 v[136:139], v1, s[12:15], s53 offen nt
  s_mov_b32 s75, 1000000
L_wqm:
  ds_read_b128 v[8:11], v12
  s_sub_u32 s75, s75, 1
  s_cbranch_scc1 L_wqm_ok
  s_waitcnt lgkmcnt(0)
  v_max3_u32 v13, v8, v9, v10
  v_max_u32 v13, v13, v11
  v_cmp_eq_u32 vcc, -1, v13
  s_cbranch_vccnz L_wqm
L_wqm_ok:
  s_waitcnt lgkmcnt(0)
  s_and_b32 s29, s28, 0x7f7f7f7f
  s_add_u32 s29, s29, 0x07050301
  s_and_b32 s30, s28, 0x80808080
  s_xor_b32 s29, s29, s30
  s_bfe_u32 s60, s29, 0x80000
  s_bfe_u32 s61, s29, 0x80008
  s_bfe_u32 s62, s29, 0x80010
  s_bfe_u32 s63, s29, 0x80018
  s_mov_b32 s31, 0xffffff00
  s_waitcnt vmcnt(3)
  s_xor_b32 s53, s52, 196608
  buffer_load_dwordx4 v[140:143], v1, s[12:15], s53 offen nt
  v_mov_b32 v24, 0
  v_mov_b32 v25, 0
  v_mov_b32 v26, 0
  v_mov_b32 v27, 0
  v_mov_b32 v28, 0
  v_mov_b32 v29, 0
  v_mov_b32 v30, 0
  v_mov_b32 v31, 0
  v_mov_b32 v32, 0
  v_mov_b32 v33, 0
  v_mov_b32 v34, 0
  v_mov_b32 v35, 0
  v_mov_b32 v36, 0
  v_mov_b32 v37, 0
  v_mov_b32 v38, 0
  v_mov_b32 v39, 0
  v_dot2c_f32_bf16 v24, v44, v8
  v_dot2c_f32_bf16 v24, v45, v9
  v_dot2c_f32_bf16 v24, v46, v10
  v_dot2c_f32_bf16 v24, v47, v11
  v_dot2c_f32_bf16 v25, v48, v8
  v_dot2c_f32_bf16 v25, v49, v9
  v_dot2c_f32_bf16 v25, v50, v10
  v_dot2c_f32_bf16 v25, v51, v11
  v_dot2c_f32_bf16 v26, v52, v8
  v_dot2c_f32_bf16 v26, v53, v9
  v_dot2c_f32_bf16 v26, v54, v10
  v_dot2c_f32_bf16 v26, v55, v11
  v_dot2c_f32_bf16 v27, v56, v8
  v_dot2c_f32_bf16 v27, v57, v9
  v_dot2c_f32_bf16 v27, v58, v10
  v_dot2c_f32_bf16 v27, v59, v11
  s_waitcnt vmcnt(3)
  s_xor_b32 s53, s52, 197632
  buffer_load_dwordx4 v[144:147], v1, s[12:15], s53 offen nt
  v_dot2c_f32_bf16 v28, v60, v8
  v_dot2c_f32_bf16 v28, v61, v9
  v_dot2c_f32_bf16 v28, v62, v10
  v_dot2c_f32_bf16 v28, v63, v11
  v_dot2c_f32_bf16 v29, v64, v8
  v_dot2c_f32_bf16 v29, v65, v9
  v_dot2c_f32_bf16 v29, v66, v10
  v_dot2c_f32_bf16 v29, v67, v11
  v_dot2c_f32_bf16 v30, v68, v8
  v_dot2c_f32_bf16 v30, v69, v9
  v_dot2c_f32_bf16 v30, v70, v10
  v_dot2c_f32_bf16 v30, v71, v11
  v_dot2c_f32_bf16 v31, v72, v8
  v_dot2c_f32_bf16 v31, v73, v9
  v_dot2c_f32_bf16 v31, v74, v10
  v_dot2c_f32_bf16 v31, v75, v11
  s_waitcnt vmcnt(3)
  s_xor_b32 s53, s52, 198656
  buffer_load_dwordx4 v[148:151], v1, s[12:15], s53 offen nt
  v_dot2c_f32_bf16 v32, v76, v8
  v_dot2c_f32_bf16 v32, v77, v9
  v_dot2c_f32_bf16 v32, v78, v10
  v_dot2c_f32_bf16 v32, v79, v11
  v_dot2c_f32_bf16 v33, v80, v8
  v_dot2c_f32_bf16 v33, v81, v9
  v_dot2c_f32_bf16 v33, v82, v10
  v_dot2c_f32_bf16 v33, v83, v11
  v_dot2c_f32_bf16 v34, v84, v8
  v_dot2c_f32_bf16 v34, v85, v9
  v_dot2c_f32_bf16 v34, v86, v10
  v_dot2c_f32_bf16 v34, v87, v11
  v_dot2c_f32_bf16 v35, v88, v8
  v_dot2c_f32_bf16 v35, v89, v9
  v_dot2c_f32_bf16 v35, v90, v10
  v_dot2c_f32_bf16 v35, v91, v11
  s_waitcnt vmcnt(3)
  s_xor_b32 s53, s52, 199680
  buffer_load_dwordx4 v[152:155], v1, s[12:15], s53 offen nt
  v_dot2c_f32_bf16 v36, v92, v8
  v_dot2c_f32_bf16 v36, v93, v9
  v_dot2c_f32_bf16 v36, v94, v10
  v_dot2c_f32_bf16 v36, v95, v11
  v_dot2c_f32_bf16 v37, v96, v8
  v_dot2c_f32_bf16 v37, v97, v9
  v_dot2c_f32_bf16 v37, v98, v10
  v_dot2c_f32_bf16 v37, v99, v11
  v_dot2c_f32_bf16 v38, v100, v8
  v_dot2c_f32_bf16 v38, v101, v9
  v_dot2c_f32_bf16 v38, v102, v10
  v_dot2c_f32_bf16 v38, v103, v11
  s_xor_b32 s53, s52, 229376
  buffer_load_dwordx4 v[156:159], v1, s[12:15], s53 offen nt
  v_dot2c_f32_bf16 v39, v104, v8
  v_dot2c_f32_bf16 v39, v105, v9
  v_dot2c_f32_bf16 v39, v106, v10
  v_dot2c_f32_bf16 v39, v107, v11
  v_add_f32_dpp v24, v24, v24 row_ror:8 row_mask:0xf bank_mask:0x3
  v_add_f32_dpp v25, v25, v25 row_ror:8 row_mask:0xf bank_mask:0x3
  v_add_f32_dpp v26, v26, v26 row_ror:8 row_mask:0xf bank_mask:0x3
  v_add_f32_dpp v27, v27, v27 row_ror:8 row_mask:0xf bank_mask:0x3
  v_add_f32_dpp v28, v28, v28 row_ror:8 row_mask:0xf bank_mask:0x3
  v_add_f32_dpp v29, v29, v29 row_ror:8 row_mask:0xf bank_mask:0x3
  v_add_f32_dpp v30, v30, v30 row_ror:8 row_mask:0xf bank_mask:0x3
  v_add_f32_dpp v31, v31, v31 row_ror:8 row_mask:0xf bank_mask:0x3
  v_add_f32_dpp v24, v32, v32 row_ror:8 row_mask:0xf bank_mask:0xc
  v_add_f32_dpp v25, v33, v33 row_ror:8 row_mask:0xf bank_mask:0xc
  v_add_f32_dpp v26, v34, v34 row_ror:8 row_mask:0xf bank_mask:0xc
  v_add_f32_dpp v27, v35, v35 row_ror:8 row_mask:0xf bank_mask:0xc
  v_add_f32_dpp v28, v36, v36 row_ror:8 row_mask:0xf bank_mask:0xc
  v_add_f32_dpp v29, v37, v37 row_ror:8 row_mask:0xf bank_mask:0xc
  v_add_f32_dpp v30, v38, v38 row_ror:8 row_mask:0xf bank_mask:0xc
  v_add_f32_dpp v31, v39, v39 row_ror:8 row_mask:0xf bank_mask:0xc
  v_add_f32_dpp v24, v24, v24 row_half_mirror row_mask:0xf bank_mask:0x5
  v_add_f32_dpp v25, v25, v25 row_half_mirror row_mask:0xf bank_mask:0x5
  v_add_f32_dpp v26, v26, v26 row_half_mirror row_mask:0xf bank_mask:0x5
  v_add_f32_dpp v27, v27, v27 row_half_mirror row_mask:0xf bank_mask:0x5
  v_add_f32_dpp v24, v28, v28 row_half_mirror row_mask:0xf bank_mask:0xa
  v_add_f32_dpp v25, v29, v29 row_half_mirror row_mask:0xf bank_mask:0xa
  v_add_f32_dpp v26, v30, v30 row_half_mirror row_mask:0xf bank_mask:0xa
  v_add_f32_dpp v27, v31, v31 row_half_mirror row_mask:0xf bank_mask:0xa
  v_add_f32_dpp v24, v24, v24 quad_perm:[2,3,0,1] row_mask:0xf bank_mask:0xf
  v_add_f32_dpp v25, v25, v25 quad_perm:[2,3,0,1] row_mask:0xf bank_mask:0xf
  v_add_f32_dpp v26, v26, v26 quad_perm:[2,3,0,1] row_mask:0xf bank_mask:0xf
  v_add_f32_dpp v27, v27, v27 quad_perm:[2,3,0,1] row_mask:0xf bank_mask:0xf
  v_cndmask_b32 v24, v24, v26, s[64:65]
  v_cndmask_b32 v25, v25, v27, s[64:65]
  s_nop 0
  v_add_f32_dpp v24, v24, v24 quad_perm:[1,0,3,2] row_mask:0xf bank_mask:0xf
  v_add_f32_dpp v25, v25, v25 quad_perm:[1,0,3,2] row_mask:0xf bank_mask:0xf
  v_cndmask_b32 v2, v24, v25, s[66:67]
  v_cvt_pk_bf16_f32 v2, v2, v2
  v_lshlrev_b32 v2, 16, v2
  v_mul_f32 v2, 0x3db504f3, v2
  v_cvt_pk_bf16_f32 v2, v2, v2
  v_lshlrev_b32 v2, 16, v2
  s_waitcnt vmcnt(4)
  v_mov_b32 v24, 0
  v_mov_b32 v25, 0
  v_mov_b32 v26, 0
  v_mov_b32 v27, 0
  v_mov_b32 v28, 0
  v_mov_b32 v29, 0
  v_mov_b32 v30, 0
  v_mov_b32 v31, 0
  v_mov_b32 v32, 0
  v_mov_b32 v33, 0
  v_mov_b32 v34, 0
  v_mov_b32 v35, 0
  v_mov_b32 v36, 0
  v_mov_b32 v37, 0
  v_mov_b32 v38, 0
  v_mov_b32 v39, 0
  v_dot2c_f32_bf16 v24, v108, v8
  v_dot2c_f32_bf16 v24, v109, v9
  v_dot2c_f32_bf16 v24, v110, v10
  v_dot2c_f32_bf16 v24, v111, v11
  v_dot2c_f32_bf16 v25, v112, v8
  v_dot2c_f32_bf16 v25, v113, v9
  v_dot2c_f32_bf16 v25, v114, v10
  v_dot2c_f32_bf16 v25, v115, v11
  v_dot2c_f32_bf16 v26, v116, v8
  v_dot2c_f32_bf16 v26, v117, v9
  v_dot2c_f32_bf16 v26, v118, v10
  v_dot2c_f32_bf16 v26, v119, v11
  v_dot2c_f32_bf16 v27, v120, v8
  v_dot2c_f32_bf16 v27, v121, v9
  v_dot2c_f32_bf16 v27, v122, v10
  v_dot2c_f32_bf16 v27, v123, v11
  s_waitcnt vmcnt(3)
  s_xor_b32 s53, s52, 230400
  buffer_load_dwordx4 v[160:163], v1, s[12:15], s53 offen nt
  v_dot2c_f32_bf16 v28, v124, v8
  v_dot2c_f32_bf16 v28, v125, v9
  v_dot2c_f32_bf16 v28, v126, v10
  v_dot2c_f32_bf16 v28, v127, v11
  v_dot2c_f32_bf16 v29, v128, v8
  v_dot2c_f32_bf16 v29, v129, v9
  v_dot2c_f32_bf16 v29, v130, v10
  v_dot2c_f32_bf16 v29, v131, v11
  v_dot2c_f32_bf16 v30, v132, v8
  v_dot2c_f32_bf16 v30, v133, v9
  v_dot2c_f32_bf16 v30, v134, v10
  v_dot2c_f32_bf16 v30, v135, v11
  v_dot2c_f32_bf16 v31, v136, v8
  v_dot2c_f32_bf16 v31, v137, v9
  v_dot2c_f32_bf16 v31, v138, v10
  v_dot2c_f32_bf16 v31, v139, v11
  s_waitcnt vmcnt(3)
  s_xor_b32 s53, s52, 231424
  buffer_load_dwordx4 v[164:167], v1, s[12:15], s53 offen nt
  v_dot2c_f32_bf16 v32, v140, v8
  v_dot2c_f32_bf16 v32, v141, v9
  v_dot2c_f32_bf16 v32, v142, v10
  v_dot2c_f32_bf16 v32, v143, v11
  v_dot2c_f32_bf16 v33, v144, v8
  v_dot2c_f32_bf16 v33, v145, v9
  v_dot2c_f32_bf16 v33, v146, v10
  v_dot2c_f32_bf16 v33, v147, v11
  v_dot2c_f32_bf16 v34, v148, v8
  v_dot2c_f32_bf16 v34, v149, v9
  v_dot2c_f32_bf16 v34, v150, v10
  v_dot2c_f32_bf16 v34, v151, v11
  s_waitcnt vmcnt(3)
  s_xor_b32 s53, s52, 232448
  buffer_load_dwordx4 v[44:47], v1, s[12:15], s53 offen nt
  v_dot2c_f32_bf16 v35, v152, v8
  v_dot2c_f32_bf16 v35, v153, v9
  v_dot2c_f32_bf16 v35, v154, v10
  v_dot2c_f32_bf16 v35, v155, v11
  s_waitcnt vmcnt(3)
  buffer_load_dwordx4 v[48:51], v1, s[16:19], s52 offen nt
  v_dot2c_f32_bf16 v36, v156, v8
  v_dot2c_f32_bf16 v36, v157, v9
  v_dot2c_f32_bf16 v36, v158, v10
  v_dot2c_f32_bf16 v36, v159, v11
  s_waitcnt vmcnt(3)
  s_xor_b32 s53, s52, 1024
  buffer_load_dwordx4 v[52:55], v1, s[16:19], s53 offen nt
  v_dot2c_f32_bf16 v37, v160, v8
  v_dot2c_f32_bf16 v37, v161, v9
  v_dot2c_f32_bf16 v37, v162, v10
  v_dot2c_f32_bf16 v37, v163, v11
  s_waitcnt vmcnt(3)
  s_xor_b32 s53, s52, 2048
  buffer_load_dwordx4 v[56:59], v1, s[16:19], s53 offen nt
  v_dot2c_f32_bf16 v38, v164, v8
  v_dot2c_f32_bf16 v38, v165, v9
  v_dot2c_f32_bf16 v38, v166, v10
  v_dot2c_f32_bf16 v38, v167, v11
  s_waitcnt vmcnt(3)
  s_xor_b32 s53, s52, 3072
  buffer_load_dwordx4 v[60:63], v1, s[16:19], s53 offen nt
  s_xor_b32 s53, s52, 32768
  buffer_load_dwordx4 v[64:67], v1, s[16:19], s53 offen nt
  v_dot2c_f32_bf16 v39, v44, v8
  v_dot2c_f32_bf16 v39, v45, v9
  v_dot2c_f32_bf16 v39, v46, v10
  v_dot2c_f32_bf16 v39, v47, v11
  v_add_f32_dpp v24, v24, v24 row_ror:8 row_mask:0xf bank_mask:0x3
  v_add_f32_dpp v25, v25, v25 row_ror:8 row_mask:0xf bank_mask:0x3
  v_add_f32_dpp v26, v26, v26 row_ror:8 row_mask:0xf bank_mask:0x3
  v_add_f32_dpp v27, v27, v27 row_ror:8 row_mask:0xf bank_mask:0x3
  v_add_f32_dpp v28, v28, v28 row_ror:8 row_mask:0xf bank_mask:0x3
  v_add_f32_dpp v29, v29, v29 row_ror:8 row_mask:0xf bank_mask:0x3
  v_add_f32_dpp v30, v30, v30 row_ror:8 row_mask:0xf bank_mask:0x3
  v_add_f32_dpp v31, v31, v31 row_ror:8 row_mask:0xf bank_mask:0x3
  v_add_f32_dpp v24, v32, v32 row_ror:8 row_mask:0xf bank_mask:0xc
  v_add_f32_dpp v25, v33, v33 row_ror:8 row_mask:0xf bank_mask:0xc
  v_add_f32_dpp v26, v34, v34 row_ror:8 row_mask:0xf bank_mask:0xc
  v_add_f32_dpp v27, v35, v35 row_ror:8 row_mask:0xf bank_mask:0xc
  v_add_f32_dpp v28, v36, v36 row_ror:8 row_mask:0xf bank_mask:0xc
  v_add_f32_dpp v29, v37, v37 row_ror:8 row_mask:0xf bank_mask:0xc
  v_add_f32_dpp v30, v38, v38 row_ror:8 row_mask:0xf bank_mask:0xc
  v_add_f32_dpp v31, v39, v39 row_ror:8 row_mask:0xf bank_mask:0xc
  v_add_f32_dpp v24, v24, v24 row_half_mirror row_mask:0xf bank_mask:0x5
  v_add_f32_dpp v25, v25, v25 row_half_mirror row_mask:0xf bank_mask:0x5
  v_add_f32_dpp v26, v26, v26 row_half_mirror row_mask:0xf bank_mask:0x5
  v_add_f32_dpp v27, v27, v27 row_half_mirror row_mask:0xf bank_mask:0x5
  v_add_f32_dpp v24, v28, v28 row_half_mirror row_mask:0xf bank_mask:0xa
  v_add_f32_dpp v25, v29, v29 row_half_mirror row_mask:0xf bank_mask:0xa
  v_add_f32_dpp v26, v30, v30 row_half_mirror row_mask:0xf bank_mask:0xa
  v_add_f32_dpp v27, v31, v31 row_half_mirror row_mask:0xf bank_mask:0xa
  v_add_f32_dpp v24, v24, v24 quad_perm:[2,3,0,1] row_mask:0xf bank_mask:0xf
  v_add_f32_dpp v25, v25, v25 quad_perm:[2,3,0,1] row_mask:0xf bank_mask:0xf
  v_add_f32_dpp v26, v26, v26 quad_perm:[2,3,0,1] row_mask:0xf bank_mask:0xf
  v_add_f32_dpp v27, v27, v27 quad_perm:[2,3,0,1] row_mask:0xf bank_mask:0xf
  v_cndmask_b32 v24, v24, v26, s[64:65]
  v_cndmask_b32 v25, v25, v27, s[64:65]
  s_nop 0
  v_add_f32_dpp v24, v24, v24 quad_perm:[1,0,3,2] row_mask:0xf bank_mask:0xf
  v_add_f32_dpp v25, v25, v25 quad_perm:[1,0,3,2] row_mask:0xf bank_mask:0xf
  v_cndmask_b32 v3, v24, v25, s[66:67]
  v_cvt_pk_bf16_f32 v3, v3, v3
  v_lshlrev_b32 v3, 16, v3
  v_mul_f32 v3, 0x3db504f3, v3
  v_cvt_pk_bf16_f32 v3, v3, v3
  v_lshlrev_b32 v3, 16, v3
  v_max_f32 v24, v2, v3
  s_nop 1
  v_max_f32_dpp v24, v24, v24 row_shr:1 row_mask:0xf bank_mask:0xf
  s_nop 1
  v_max_f32_dpp v24, v24, v24 row_shr:2 row_mask:0xf bank_mask:0xf
  s_nop 1
  v_max_f32_dpp v24, v24, v24 row_shr:4 row_mask:0xf bank_mask:0xf
  s_nop 1
  v_max_f32_dpp v24, v24, v24 row_shr:8 row_mask:0xf bank_mask:0xf
  s_nop 1
  v_max_f32_dpp v24, v24, v24 row_bcast:15 row_mask:0xa bank_mask:0xf
  s_nop 1
  v_max_f32_dpp v24, v24, v24 row_bcast:31 row_mask:0xc bank_mask:0xf
  s_nop 0
  v_readlane_b32 s72, v24, 63
  s_nop 1
  v_subrev_f32 v2, s72, v2
  v_subrev_f32 v3, s72, v3
  v_mul_f32 v2, 0x3fb8aa3b, v2
  v_mul_f32 v3, 0x3fb8aa3b, v3
  v_exp_f32 v2, v2
  v_exp_f32 v3, v3
  s_nop 0
  v_add_f32 v25, v2, v3
  v_cvt_pk_bf16_f32 v2, v2, v2
  v_cvt_pk_bf16_f32 v3, v3, v3
  v_add_f32_dpp v25, v25, v25 row_shr:1 row_mask:0xf bank_mask:0xf
  s_nop 1
  v_add_f32_dpp v25, v25, v25 row_shr:2 row_mask:0xf bank_mask:0xf
  s_nop 1
  v_add_f32_dpp v25, v25, v25 row_shr:4 row_mask:0xf bank_mask:0xf
  s_nop 1
  v_add_f32_dpp v25, v25, v25 row_shr:8 row_mask:0xf bank_mask:0xf
  s_nop 1
  v_add_f32_dpp v25, v25, v25 row_bcast:15 row_mask:0xa bank_mask:0xf
  s_nop 1
  v_add_f32_dpp v25, v25, v25 row_bcast:31 row_mask:0xc bank_mask:0xf
  s_lshl_b32 s73, s3, 3
  s_add_u32 s73, s73, 106752
  v_mov_b32 v26, s73
  s_mov_b32 exec_lo, 0
  s_mov_b32 exec_hi, 0x80000000
  ds_write_b64 v26, v[24:25]
  s_mov_b64 exec, -1
  s_lshl_b32 s73, s3, 9
  s_add_u32 s73, s73, 100352
  v_and_b32 v27, 15, v0
  v_lshrrev_b32 v28, 4, v0
  v_lshlrev_b32 v29, 5, v27
  v_lshl_add_u32 v29, v28, 4, v29
  v_add_u32 v29, s73, v29
  v_and_b32_dpp v12, v2, v4 row_newbcast:0 row_mask:0xf bank_mask:0xf
  v_and_b32_dpp v13, v2, v5 row_newbcast:0 row_mask:0xf bank_mask:0xf
  v_and_b32_dpp v14, v2, v6 row_newbcast:0 row_mask:0xf bank_mask:0xf
  v_and_b32_dpp v15, v2, v7 row_newbcast:0 row_mask:0xf bank_mask:0xf
  s_waitcnt vmcnt(4)
  s_nop 0
  v_mfma_f32_16x16x32_bf16 v[20:23], v[12:15], v[48:51], 0
  v_and_b32_dpp v16, v2, v4 row_newbcast:1 row_mask:0xf bank_mask:0xf
  v_and_b32_dpp v17, v2, v5 row_newbcast:1 row_mask:0xf bank_mask:0xf
  v_and_b32_dpp v18, v2, v6 row_newbcast:1 row_mask:0xf bank_mask:0xf
  v_and_b32_dpp v19, v2, v7 row_newbcast:1 row_mask:0xf bank_mask:0xf
  s_waitcnt vmcnt(3)
  s_xor_b32 s53, s52, 33792
  buffer_load_dwordx4 v[68:71], v1, s[16:19], s53 offen nt
  v_mfma_f32_16x16x32_bf16 v[20:23], v[16:19], v[52:55], v[20:23]
  v_and_b32_dpp v12, v2, v4 row_newbcast:2 row_mask:0xf bank_mask:0xf
  v_and_b32_dpp v13, v2, v5 row_newbcast:2 row_mask:0xf bank_mask:0xf
  v_and_b32_dpp v14, v2, v6 row_newbcast:2 row_mask:0xf bank_mask:0xf
  v_and_b32_dpp v15, v2, v7 row_newbcast:2 row_mask:0xf bank_mask:0xf
  s_waitcnt vmcnt(3)
  s_xor_b32 s53, s52, 34816
  buffer_load_dwordx4 v[72:75], v1, s[16:19], s53 offen nt
  v_mfma_f32_16x16x32_bf16 v[20:23], v[12:15], v[56:59], v[20:23]
  v_and_b32_dpp v16, v2, v4 row_newbcast:3 row_mask:0xf bank_mask:0xf
  v_and_b32_dpp v17, v2, v5 row_newbcast:3 row_mask:0xf bank_mask:0xf
  v_and_b32_dpp v18, v2, v6 row_newbcast:3 row_mask:0xf bank_mask:0xf
  v_and_b32_dpp v19, v2, v7 row_newbcast:3 row_mask:0xf bank_mask:0xf
  s_waitcnt vmcnt(3)
  s_xor_b32 s53, s52, 35840
  buffer_load_dwordx4 v[76:79], v1, s[16:19], s53 offen nt
  v_mfma_f32_16x16x32_bf16 v[20:23], v[16:19], v[60:63], v[20:23]
  v_and_b32_dpp v12, v2, v4 row_newbcast:4 row_mask:0xf bank_mask:0xf
  v_and_b32_dpp v13, v2, v5 row_newbcast:4 row_mask:0xf bank_mask:0xf
  v_and_b32_dpp v14, v2, v6 row_newbcast:4 row_mask:0xf bank_mask:0xf
  v_and_b32_dpp v15, v2, v7 row_newbcast:4 row_mask:0xf bank_mask:0xf
  s_waitcnt vmcnt(3)
  s_xor_b32 s53, s52, 65536
  buffer_load_dwordx4 v[80:83], v1, s[16:19], s53 offen nt
  v_mfma_f32_16x16x32_bf16 v[20:23], v[12:15], v[64:67], v[20:23]
  v_and_b32_dpp v16, v2, v4 row_newbcast:5 row_mask:0xf bank_mask:0xf
  v_and_b32_dpp v17, v2, v5 row_newbcast:5 row_mask:0xf bank_mask:0xf
  v_and_b32_dpp v18, v2, v6 row_newbcast:5 row_mask:0xf bank_mask:0xf
  v_and_b32_dpp v19, v2, v7 row_newbcast:5 row_mask:0xf bank_mask:0xf
  s_waitcnt vmcnt(3)
  s_xor_b32 s53, s52, 66560
  buffer_load_dwordx4 v[84:87], v1, s[16:19], s53 offen nt
  v_mfma_f32_16x16x32_bf16 v[20:23], v[16:19], v[68:71], v[20:23]
  v_and_b32_dpp v12, v2, v4 row_newbcast:6 row_mask:0xf bank_mask:0xf
  v_and_b32_dpp v13, v2, v5 row_newbcast:6 row_mask:0xf bank_mask:0xf
  v_and_b32_dpp v14, v2, v6 row_newbcast:6 row_mask:0xf bank_mask:0xf
  v_and_b32_dpp v15, v2, v7 row_newbcast:6 row_mask:0xf bank_mask:0xf
  s_waitcnt vmcnt(3)
  s_xor_b32 s53, s52, 67584
  buffer_load_dwordx4 v[88:91], v1, s[16:19], s53 offen nt
  v_mfma_f32_16x16x32_bf16 v[20:23], v[12:15], v[72:75], v[20:23]
  v_and_b32_dpp v16, v2, v4 row_newbcast:7 row_mask:0xf bank_mask:0xf
  v_and_b32_dpp v17, v2, v5 row_newbcast:7 row_mask:0xf bank_mask:0xf
  v_and_b32_dpp v18, v2, v6 row_newbcast:7 row_mask:0xf bank_mask:0xf
  v_and_b32_dpp v19, v2, v7 row_newbcast:7 row_mask:0xf bank_mask:0xf
  s_waitcnt vmcnt(3)
  s_xor_b32 s53, s52, 68608
  buffer_load_dwordx4 v[92:95], v1, s[16:19], s53 offen nt
  v_mfma_f32_16x16x32_bf16 v[20:23], v[16:19], v[76:79], v[20:23]
  v_and_b32_dpp v12, v2, v4 row_newbcast:8 row_mask:0xf bank_mask:0xf
  v_and_b32_dpp v13, v2, v5 row_newbcast:8 row_mask:0xf bank_mask:0xf
  v_and_b32_dpp v14, v2, v6 row_newbcast:8 row_mask:0xf bank_mask:0xf
  v_and_b32_dpp v15, v2, v7 row_newbcast:8 row_mask:0xf bank_mask:0xf
  s_waitcnt vmcnt(3)
  s_xor_b32 s53, s52, 98304
  buffer_load_dwordx4 v[96:99], v1, s[16:19], s53 offen nt
  v_mfma_f32_16x16x32_bf16 v[20:23], v[12:15], v[80:83], v[20:23]
  v_and_b32_dpp v16, v2, v4 row_newbcast:9 row_mask:0xf bank_mask:0xf
  v_and_b32_dpp v17, v2, v5 row_newbcast:9 row_mask:0xf bank_mask:0xf
  v_and_b32_dpp v18, v2, v6 row_newbcast:9 row_mask:0xf bank_mask:0xf
  v_and_b32_dpp v19, v2, v7 row_newbcast:9 row_mask:0xf bank_mask:0xf
  s_waitcnt vmcnt(3)
  s_xor_b32 s53, s52, 99328
  buffer_load_dwordx4 v[100:103], v1, s[16:19], s53 offen nt
  v_mfma_f32_16x16x32_bf16 v[20:23], v[16:19], v[84:87], v[20:23]
  v_and_b32_dpp v12, v2, v4 row_newbcast:10 row_mask:0xf bank_mask:0xf
  v_and_b32_dpp v13, v2, v5 row_newbcast:10 row_mask:0xf bank_mask:0xf
  v_and_b32_dpp v14, v2, v6 row_newbcast:10 row_mask:0xf bank_mask:0xf
  v_and_b32_dpp v15, v2, v7 row_newbcast:10 row_mask:0xf bank_mask:0xf
  s_waitcnt vmcnt(3)
  s_xor_b32 s53, s52, 100352
  buffer_load_dwordx4 v[104:107], v1, s[16:19], s53 offen nt
  v_mfma_f32_16x16x32_bf16 v[20:23], v[12:15], v[88:91], v[20:23]
  v_and_b32_dpp v16, v2, v4 row_newbcast:11 row_mask:0xf bank_mask:0xf
  v_and_b32_dpp v17, v2, v5 row_newbcast:11 row_mask:0xf bank_mask:0xf
  v_and_b32_dpp v18, v2, v6 row_newbcast:11 row_mask:0xf bank_mask:0xf
  v_and_b32_dpp v19, v2, v7 row_newbcast:11 row_mask:0xf bank_mask:0xf
  s_waitcnt vmcnt(3)
  s_xor_b32 s53, s52, 101376
  buffer_load_dwordx4 v[108:111], v1, s[16:19], s53 offen nt
  v_mfma_f32_16x16x32_bf16 v[20:23], v[16:19], v[92:95], v[20:23]
  v_and_b32_dpp v12, v2, v4 row_newbcast:12 row_mask:0xf bank_mask:0xf
  v_and_b32_dpp v13, v2, v5 row_newbcast:12 row_mask:0xf bank_mask:0xf
  v_and_b32_dpp v14, v2, v6 row_newbcast:12 row_mask:0xf bank_mask:0xf
  v_and_b32_dpp v15, v2, v7 row_newbcast:12 row_mask:0xf bank_mask:0xf
  s_waitcnt vmcnt(3)
  s_xor_b32 s53, s52, 131072
  buffer_load_dwordx4 v[112:115], v1, s[16:19], s53 offen nt
  v_mfma_f32_16x16x32_bf16 v[20:23], v[12:15], v[96:99], v[20:23]
  v_bfe_u32 v38, v0, 2, 1
  v_bfe_u32 v31, v0, 3, 2
  v_lshlrev_b32 v30, 5, v31
  v_and_b32 v31, 3, v0
  v_lshl_add_u32 v30, v31, 3, v30
  s_lshl_b32 s73, s3, 7
  v_add_u32 v30, s73, v30
  v_lshrrev_b32 v39, 5, v0
  v_lshl_add_u32 v30, v39, 2, v30
  v_lshl_add_u32 v39, v38, 10, v30
  buffer_load_dword v36, v39, s[4:7], 0 offen
  v_lshlrev_b32 v39, 10, v38
  buffer_load_ushort v41, v39, s[4:7], 0 offen
  buffer_load_dwordx4 v[32:35], v1, s[44:47], 0 offen
  v_mul_u32_u24 v39, 1088, v38
  v_add_u32 v30, v30, v39
  v_add_u32 v30, 107776, v30
  v_lshrrev_b32 v39, 4, v0
  v_lshlrev_b32 v39, 3, v39
  v_lshl_add_u32 v39, v38, 8, v39
  s_lshl_b32 s73, s3, 5
  s_add_u32 s73, s73, 110080
  v_add_u32 v39, s73, v39
  s_lshl_b32 s78, s3, 12
  s_add_u32 s78, s78, 299008
  v_lshrrev_b32 v42, 2, v0
  v_mul_u32_u24 v42, 2752, v42
  v_lshl_add_u32 v42, v31, 4, v42
  s_and_b32 s70, s2, 7
  s_min_u32 s71, s70, 3
  s_mul_i32 s70, s70, 5
  s_add_u32 s70, s70, s71
  s_lshr_b32 s71, s2, 3
  s_add_u32 s70, s70, s71
  s_mov_b32 s74, s3
  s_mul_i32 s68, s74, 176128
  s_lshl_b32 s69, s70, 6
  s_add_u32 s68, s68, s69
  s_lshl_b32 s69, s74, 12
  s_lshl_b32 s70, s70, 15
  s_add_u32 s70, s70, s69
  s_mul_i32 s71, s74, 4224
  v_and_b32_dpp v16, v2, v4 row_newbcast:13 row_mask:0xf bank_mask:0xf
  v_and_b32_dpp v17, v2, v5 row_newbcast:13 row_mask:0xf bank_mask:0xf
  v_and_b32_dpp v18, v2, v6 row_newbcast:13 row_mask:0xf bank_mask:0xf
  v_and_b32_dpp v19, v2, v7 row_newbcast:13 row_mask:0xf bank_mask:0xf
  s_waitcnt vmcnt(6)
  s_xor_b32 s53, s52, 132096
  buffer_load_dwordx4 v[116:119], v1, s[16:19], s53 offen nt
  v_mfma_f32_16x16x32_bf16 v[20:23], v[16:19], v[100:103], v[20:23]
  v_and_b32_dpp v12, v2, v4 row_newbcast:14 row_mask:0xf bank_mask:0xf
  v_and_b32_dpp v13, v2, v5 row_newbcast:14 row_mask:0xf bank_mask:0xf
  v_and_b32_dpp v14, v2, v6 row_newbcast:14 row_mask:0xf bank_mask:0xf
  v_and_b32_dpp v15, v2, v7 row_newbcast:14 row_mask:0xf bank_mask:0xf
  s_waitcnt vmcnt(6)
  s_xor_b32 s53, s52, 133120
  buffer_load_dwordx4 v[120:123], v1, s[16:19], s53 offen nt
  v_mfma_f32_16x16x32_bf16 v[20:23], v[12:15], v[104:107], v[20:23]
  v_and_b32_dpp v16, v2, v4 row_newbcast:15 row_mask:0xf bank_mask:0xf
  v_and_b32_dpp v17, v2, v5 row_newbcast:15 row_mask:0xf bank_mask:0xf
  v_and_b32_dpp v18, v2, v6 row_newbcast:15 row_mask:0xf bank_mask:0xf
  v_and_b32_dpp v19, v2, v7 row_newbcast:15 row_mask:0xf bank_mask:0xf
  s_waitcnt vmcnt(6)
  s_xor_b32 s53, s52, 134144
  buffer_load_dwordx4 v[124:127], v1, s[16:19], s53 offen nt
  v_mfma_f32_16x16x32_bf16 v[20:23], v[16:19], v[108:111], v[20:23]
  v_and_b32_dpp v12, v3, v4 row_newbcast:0 row_mask:0xf bank_mask:0xf
  v_and_b32_dpp v13, v3, v5 row_newbcast:0 row_mask:0xf bank_mask:0xf
  v_and_b32_dpp v14, v3, v6 row_newbcast:0 row_mask:0xf bank_mask:0xf
  v_and_b32_dpp v15, v3, v7 row_newbcast:0 row_mask:0xf bank_mask:0xf
  s_waitcnt vmcnt(6)
  s_xor_b32 s53, s52, 163840
  buffer_load_dwordx4 v[128:131], v1, s[16:19], s53 offen nt
  v_mfma_f32_16x16x32_bf16 v[20:23], v[12:15], v[112:115], v[20:23]
  v_and_b32_dpp v16, v3, v4 row_newbcast:1 row_mask:0xf bank_mask:0xf
  v_and_b32_dpp v17, v3, v5 row_newbcast:1 row_mask:0xf bank_mask:0xf
  v_and_b32_dpp v18, v3, v6 row_newbcast:1 row_mask:0xf bank_mask:0xf
  v_and_b32_dpp v19, v3, v7 row_newbcast:1 row_mask:0xf bank_mask:0xf
  s_waitcnt vmcnt(3)
  s_xor_b32 s53, s52, 164864
  buffer_load_dwordx4 v[132:135], v1, s[16:19], s53 offen nt
  v_mfma_f32_16x16x32_bf16 v[20:23], v[16:19], v[116:119], v[20:23]
  v_and_b32_dpp v12, v3, v4 row_newbcast:2 row_mask:0xf bank_mask:0xf
  v_and_b32_dpp v13, v3, v5 row_newbcast:2 row_mask:0xf bank_mask:0xf
  v_and_b32_dpp v14, v3, v6 row_newbcast:2 row_mask:0xf bank_mask:0xf
  v_and_b32_dpp v15, v3, v7 row_newbcast:2 row_mask:0xf bank_mask:0xf
  s_waitcnt vmcnt(3)
  s_xor_b32 s53, s52, 165888
  buffer_load_dwordx4 v[136:139], v1, s[16:19], s53 offen nt
  v_mfma_f32_16x16x32_bf16 v[20:23], v[12:15], v[120:123], v[20:23]
  v_and_b32_dpp v16, v3, v4 row_newbcast:3 row_mask:0xf bank_mask:0xf
  v_and_b32_dpp v17, v3, v5 row_newbcast:3 row_mask:0xf bank_mask:0xf
  v_and_b32_dpp v18, v3, v6 row_newbcast:3 row_mask:0xf bank_mask:0xf
  v_and_b32_dpp v19, v3, v7 row_newbcast:3 row_mask:0xf bank_mask:0xf
  s_waitcnt vmcnt(3)
  s_xor_b32 s53, s52, 166912
  buffer_load_dwordx4 v[140:143], v1, s[16:19], s53 offen nt
  v_mfma_f32_16x16x32_bf16 v[20:23], v[16:19], v[124:127], v[20:23]
  v_and_b32_dpp v12, v3, v4 row_newbcast:4 row_mask:0xf bank_mask:0xf
  v_and_b32_dpp v13, v3, v5 row_newbcast:4 row_mask:0xf bank_mask:0xf
  v_and_b32_dpp v14, v3, v6 row_newbcast:4 row_mask:0xf bank_mask:0xf
  v_and_b32_dpp v15, v3, v7 row_newbcast:4 row_mask:0xf bank_mask:0xf
  s_waitcnt vmcnt(3)
  s_xor_b32 s53, s52, 196608
  buffer_load_dwordx4 v[144:147], v1, s[16:19], s53 offen nt
  v_mfma_f32_16x16x32_bf16 v[20:23], v[12:15], v[128:131], v[20:23]
  v_and_b32_dpp v16, v3, v4 row_newbcast:5 row_mask:0xf bank_mask:0xf
  v_and_b32_dpp v17, v3, v5 row_newbcast:5 row_mask:0xf bank_mask:0xf
  v_and_b32_dpp v18, v3, v6 row_newbcast:5 row_mask:0xf bank_mask:0xf
  v_and_b32_dpp v19, v3, v7 row_newbcast:5 row_mask:0xf bank_mask:0xf
  s_waitcnt vmcnt(3)
  s_xor_b32 s53, s52, 197632
  buffer_load_dwordx4 v[148:151], v1, s[16:19], s53 offen nt
  v_mfma_f32_16x16x32_bf16 v[20:23], v[16:19], v[132:135], v[20:23]
  v_and_b32_dpp v12, v3, v4 row_newbcast:6 row_mask:0xf bank_mask:0xf
  v_and_b32_dpp v13, v3, v5 row_newbcast:6 row_mask:0xf bank_mask:0xf
  v_and_b32_dpp v14, v3, v6 row_newbcast:6 row_mask:0xf bank_mask:0xf
  v_and_b32_dpp v15, v3, v7 row_newbcast:6 row_mask:0xf bank_mask:0xf
  s_waitcnt vmcnt(3)
  s_xor_b32 s53, s52, 198656
  buffer_load_dwordx4 v[152:155], v1, s[16:19], s53 offen nt
  v_mfma_f32_16x16x32_bf16 v[20:23], v[12:15], v[136:139], v[20:23]
  v_and_b32_dpp v16, v3, v4 row_newbcast:7 row_mask:0xf bank_mask:0xf
  v_and_b32_dpp v17, v3, v5 row_newbcast:7 row_mask:0xf bank_mask:0xf
  v_and_b32_dpp v18, v3, v6 row_newbcast:7 row_mask:0xf bank_mask:0xf
  v_and_b32_dpp v19, v3, v7 row_newbcast:7 row_mask:0xf bank_mask:0xf
  s_waitcnt vmcnt(3)
  s_xor_b32 s53, s52, 199680
  buffer_load_dwordx4 v[156:159], v1, s[16:19], s53 offen nt
  v_mfma_f32_16x16x32_bf16 v[20:23], v[16:19], v[140:143], v[20:23]
  v_and_b32_dpp v12, v3, v4 row_newbcast:8 row_mask:0xf bank_mask:0xf
  v_and_b32_dpp v13, v3, v5 row_newbcast:8 row_mask:0xf bank_mask:0xf
  v_and_b32_dpp v14, v3, v6 row_newbcast:8 row_mask:0xf bank_mask:0xf
  v_and_b32_dpp v15, v3, v7 row_newbcast:8 row_mask:0xf bank_mask:0xf
  s_waitcnt vmcnt(3)
  s_xor_b32 s53, s52, 229376
  buffer_load_dwordx4 v[160:163], v1, s[16:19], s53 offen nt
  v_mfma_f32_16x16x32_bf16 v[20:23], v[12:15], v[144:147], v[20:23]
  v_and_b32_dpp v16, v3, v4 row_newbcast:9 row_mask:0xf bank_mask:0xf
  v_and_b32_dpp v17, v3, v5 row_newbcast:9 row_mask:0xf bank_mask:0xf
  v_and_b32_dpp v18, v3, v6 row_newbcast:9 row_mask:0xf bank_mask:0xf
  v_and_b32_dpp v19, v3, v7 row_newbcast:9 row_mask:0xf bank_mask:0xf
  s_waitcnt vmcnt(3)
  s_xor_b32 s53, s52, 230400
  buffer_load_dwordx4 v[164:167], v1, s[16:19], s53 offen nt
  v_mfma_f32_16x16x32_bf16 v[20:23], v[16:19], v[148:151], v[20:23]
  v_and_b32_dpp v12, v3, v4 row_newbcast:10 row_mask:0xf bank_mask:0xf
  v_and_b32_dpp v13, v3, v5 row_newbcast:10 row_mask:0xf bank_mask:0xf
  v_and_b32_dpp v14, v3, v6 row_newbcast:10 row_mask:0xf bank_mask:0xf
  v_and_b32_dpp v15, v3, v7 row_newbcast:10 row_mask:0xf bank_mask:0xf
  s_waitcnt vmcnt(3)
  s_xor_b32 s53, s52, 231424
  buffer_load_dwordx4 v[44:47], v1, s[16:19], s53 offen nt
  v_mfma_f32_16x16x32_bf16 v[20:23], v[12:15], v[152:155], v[20:23]
  v_and_b32_dpp v16, v3, v4 row_newbcast:11 row_mask:0xf bank_mask:0xf
  v_and_b32_dpp v17, v3, v5 row_newbcast:11 row_mask:0xf bank_mask:0xf
  v_and_b32_dpp v18, v3, v6 row_newbcast:11 row_mask:0xf bank_mask:0xf
  v_and_b32_dpp v19, v3, v7 row_newbcast:11 row_mask:0xf bank_mask:0xf
  s_waitcnt vmcnt(3)
  s_xor_b32 s53, s52, 232448
  buffer_load_dwordx4 v[48:51], v1, s[16:19], s53 offen nt
  v_mfma_f32_16x16x32_bf16 v[20:23], v[16:19], v[156:159], v[20:23]
  v_and_b32_dpp v12, v3, v4 row_newbcast:12 row_mask:0xf bank_mask:0xf
  v_and_b32_dpp v13, v3, v5 row_newbcast:12 row_mask:0xf bank_mask:0xf
  v_and_b32_dpp v14, v3, v6 row_newbcast:12 row_mask:0xf bank_mask:0xf
  v_and_b32_dpp v15, v3, v7 row_newbcast:12 row_mask:0xf bank_mask:0xf
  s_waitcnt vmcnt(3)
  s_nop 0
  v_mfma_f32_16x16x32_bf16 v[20:23], v[12:15], v[160:163], v[20:23]
  v_and_b32_dpp v16, v3, v4 row_newbcast:13 row_mask:0xf bank_mask:0xf
  v_and_b32_dpp v17, v3, v5 row_newbcast:13 row_mask:0xf bank_mask:0xf
  v_and_b32_dpp v18, v3, v6 row_newbcast:13 row_mask:0xf bank_mask:0xf
  v_and_b32_dpp v19, v3, v7 row_newbcast:13 row_mask:0xf bank_mask:0xf
  s_waitcnt vmcnt(2)
  s_nop 0
  v_mfma_f32_16x16x32_bf16 v[20:23], v[16:19], v[164:167], v[20:23]
  v_and_b32_dpp v12, v3, v4 row_newbcast:14 row_mask:0xf bank_mask:0xf
  v_and_b32_dpp v13, v3, v5 row_newbcast:14 row_mask:0xf bank_mask:0xf
  v_and_b32_dpp v14, v3, v6 row_newbcast:14 row_mask:0xf bank_mask:0xf
  v_and_b32_dpp v15, v3, v7 row_newbcast:14 row_mask:0xf bank_mask:0xf
  s_waitcnt vmcnt(1)
  s_nop 0
  v_mfma_f32_16x16x32_bf16 v[20:23], v[12:15], v[44:47], v[20:23]
  v_and_b32_dpp v16, v3, v4 row_newbcast:15 row_mask:0xf bank_mask:0xf
  v_and_b32_dpp v17, v3, v5 row_newbcast:15 row_mask:0xf bank_mask:0xf
  v_and_b32_dpp v18, v3, v6 row_newbcast:15 row_mask:0xf bank_mask:0xf
  v_and_b32_dpp v19, v3, v7 row_newbcast:15 row_mask:0xf bank_mask:0xf
  s_waitcnt vmcnt(0)
  s_nop 0
  v_mfma_f32_16x16x32_bf16 v[20:23], v[16:19], v[48:51], v[20:23]
  s_mov_b32 exec_hi, 0
  s_nop 6
  ds_write_b128 v29, v[20:23]
  s_mov_b64 exec, -1
  s_add_u32 m0, s69, 0
  s_add_u32 s53, s68, 0
  buffer_load_dwordx4 v42, s[32:35], s53 offen  lds
  s_add_u32 m0, s69, 32800
  s_add_u32 s53, s68, 0
  buffer_load_dwordx4 v42, s[36:39], s53 offen  lds
  s_add_u32 m0, s69, 1024
  s_add_u32 s53, s68, 44032
  buffer_load_dwordx4 v42, s[32:35], s53 offen  lds
  s_add_u32 m0, s69, 33824
  s_add_u32 s53, s68, 44032
  buffer_load_dwordx4 v42, s[36:39], s53 offen  lds
  s_add_u32 m0, s69, 2048
  s_add_u32 s53, s68, 88064
  buffer_load_dwordx4 v42, s[32:35], s53 offen  lds
  s_add_u32 m0, s69, 34848
  s_add_u32 s53, s68, 88064
  buffer_load_dwordx4 v42, s[36:39], s53 offen  lds
  s_add_u32 m0, s69, 3072
  s_add_u32 s53, s68, 132096
  buffer_load_dwordx4 v42, s[32:35], s53 offen  lds
  s_add_u32 m0, s69, 35872
  s_add_u32 s53, s68, 132096
  buffer_load_dwordx4 v42, s[36:39], s53 offen  lds
  v_lshlrev_b32 v64, 16, v36
  v_and_b32 v65, 0xffff0000, v36
  v_lshlrev_b32 v41, 16, v41
  s_waitcnt vmcnt(2)
  s_add_u32 m0, s71, 65600
  s_add_u32 s53, s70, 0
  buffer_load_dwordx4 v1, s[40:43], s53 offen  lds
  s_add_u32 m0, s71, 66656
  s_add_u32 s53, s70, 1024
  buffer_load_dwordx4 v1, s[40:43], s53 offen  lds
  s_add_u32 m0, s71, 67712
  s_add_u32 s53, s70, 2048
  buffer_load_dwordx4 v1, s[40:43], s53 offen  lds
  s_add_u32 m0, s71, 68768
  s_add_u32 s53, s70, 3072
  buffer_load_dwordx4 v1, s[40:43], s53 offen  lds
  s_waitcnt vmcnt(4)
  s_lshl_b32 s73, s74, 2
  s_add_u32 s73, s73, 106816
  v_mov_b32 v26, s73
  v_mov_b32 v27, 0
  ds_write_b32 v26, v27
L_w_mk_0:
  s_cbranch_execz L_w_mk_1
  s_mov_b64 exec, 0xff
  s_mov_b32 s75, 1000000
L_pB0:
  s_sleep 2
  buffer_load_dwordx4 v[44:47], v1, s[24:27], s78 offen sc1
  s_sub_u32 s75, s75, 1
  s_cbranch_scc1 L_pB0_ok
  s_waitcnt vmcnt(1)
L_w_mk_1:
  s_cbranch_execz L_w_mk_2
  ds_write_b32 v26, v27 offset:32
  s_waitcnt vmcnt(0)
  v_xor_b32 v44, s60, v44
  v_xor_b32 v45, s61, v45
  v_xor_b32 v46, s62, v46
  v_xor_b32 v47, s63, v47
  v_or3_b32 v60, v44, v45, v46
  v_or_b32 v60, v60, v47
  v_and_b32 v60, 0xff, v60
  v_cmp_ne_u32 vcc, 0, v60
  s_cbranch_vccnz L_pB0
L_pB0_ok:
  s_mov_b64 exec, -1
L_w_mk_2:
  s_cbranch_execz L_w_mk_3
  s_mov_b32 s75, 1000000
L_pB:
  buffer_load_dwordx4 v[44:47], v1, s[24:27], s78 offen offset:0 sc1
  buffer_load_dwordx4 v[48:51], v1, s[24:27], s78 offen offset:1024 sc1
  buffer_load_dwordx4 v[52:55], v1, s[24:27], s78 offen offset:2048 sc1
  buffer_load_dwordx4 v[56:59], v1, s[24:27], s78 offen offset:3072 sc1
  s_sub_u32 s75, s75, 1
  s_cbranch_scc1 L_pB_ok
  s_waitcnt vmcnt(0)
  v_xor_b32 v44, s60, v44
  v_xor_b32 v45, s61, v45
L_w_mk_3:
  s_cbranch_execz L_w_mk_4
  v_xor_b32 v46, s62, v46
  v_xor_b32 v47, s63, v47
  v_xor_b32 v48, s60, v48
  v_xor_b32 v49, s61, v49
  v_xor_b32 v50, s62, v50
  v_xor_b32 v51, s63, v51
  v_xor_b32 v52, s60, v52
  v_xor_b32 v53, s61, v53
  v_xor_b32 v54, s62, v54
  v_xor_b32 v55, s63, v55
  v_xor_b32 v56, s60, v56
  v_xor_b32 v57, s61, v57
  v_xor_b32 v58, s62, v58
  v_xor_b32 v59, s63, v59
  v_or3_b32 v60, v44, v45, v46
L_w_mk_4:
  s_cbranch_execz L_w_mk_5
  v_or3_b32 v60, v60, v47, v48
  v_or3_b32 v60, v60, v49, v50
  v_or3_b32 v60, v60, v51, v52
  v_or3_b32 v60, v60, v53, v54
  v_or3_b32 v60, v60, v55, v56
  v_or3_b32 v60, v60, v57, v58
  v_or_b32 v60, v60, v59
  v_and_b32 v60, 0xff, v60
L_w_mk_5:
  s_cbranch_execz L_w_mk_6
  v_cmp_ne_u32 vcc, 0, v60
  s_cbranch_vccnz L_pB
L_pB_ok:
  v_add_f32 v44, v44, v48
  v_add_f32 v52, v52, v56
  v_add_f32 v45, v45, v49
  v_add_f32 v53, v53, v57
  v_add_f32 v46, v46, v50
  v_add_f32 v54, v54, v58
  v_add_f32 v47, v47, v51
  v_add_f32 v55, v55, v59
  v_add_f32 v44, v44, v52
  v_add_f32 v45, v45, v53
  v_add_f32 v46, v46, v54
  v_add_f32 v47, v47, v55
L_w_mk_6:
  s_cbranch_execz L_w_mk_7
  s_nop 0
  v_permlane32_swap_b32 v44, v46
  v_permlane32_swap_b32 v45, v47
  v_add_f32 v44, v44, v64
  v_add_f32 v45, v45, v65
  v_add_f32 v44, v44, v46
  v_add_f32 v45, v45, v47
  v_cvt_pk_bf16_f32 v48, v44, v45
  ds_write_b32 v30, v48
  v_lshlrev_b32 v44, 16, v48
  v_and_b32 v45, 0xffff0000, v48
  v_sub_f32 v44, v44, v41
L_w_mk_7:
  s_cbranch_execz L_w_mk_8
  v_sub_f32 v45, v45, v41
  v_mul_f32 v51, v44, v44
  v_add_f32 v50, v44, v45
  v_fmac_f32 v51, v45, v45
  s_nop 0
  v_add_f32_dpp v50, v50, v50 quad_perm:[1,0,3,2] row_mask:0xf bank_mask:0xf
  v_add_f32_dpp v51, v51, v51 quad_perm:[1,0,3,2] row_mask:0xf bank_mask:0xf
  s_nop 0
  v_add_f32_dpp v50, v50, v50 quad_perm:[2,3,0,1] row_mask:0xf bank_mask:0xf
  v_add_f32_dpp v51, v51, v51 quad_perm:[2,3,0,1] row_mask:0xf bank_mask:0xf
  s_nop 0
L_w_mk_8:
  s_cbranch_execz L_w_mk_9
  v_add_f32_dpp v50, v50, v50 row_ror:8 row_mask:0xf bank_mask:0xf
  v_add_f32_dpp v51, v51, v51 row_ror:8 row_mask:0xf bank_mask:0xf
  ds_write_b64 v39, v[50:51]
  s_waitcnt lgkmcnt(0)
  s_barrier
  s_cmp_ge_u32 s3, 2
  s_cbranch_scc1 L_fin
  s_cmp_ge_u32 s2, 32
  s_cbranch_scc1 L_fin
  s_mul_i32 s73, s3, 1088
  s_add_u32 s73, s73, 107776
L_w_mk_9:
  s_cbranch_execz L_w_mk_10
  v_add_u32 v52, s73, v1
  ds_read_b128 v[96:99], v52
  v_lshrrev_b32 v40, 2, v0
  v_and_b32 v43, 3, v0
  v_lshlrev_b32 v44, 7, v40
  v_lshl_or_b32 v44, v43, 4, v44
  s_mul_i32 s78, s2, 5504
  s_lshl_b32 s73, s3, 6
  s_add_u32 s78, s78, s73
  s_add_u32 s78, s78, 856064
L_w_mk_10:
  s_cbranch_execz L_w_mk_11
  s_add_u32 s79, s78, 2048
  s_add_u32 s77, s78, 4096
  s_lshl_b32 s74, s2, 5
  s_lshl_b32 s73, s3, 4
  s_add_u32 s76, s74, s73
  v_lshlrev_b32 v45, 2, v43
  v_lshrrev_b32 v47, 5, v0
  v_lshl_add_u32 v45, v47, 1, v45
  v_bfe_u32 v47, v0, 4, 1
  v_mul_u32_u24 v46, 1088, v47
L_w_mk_11:
  s_cbranch_execz L_w_mk_12
  v_add_u32 v46, v46, v45
  s_add_u32 s73, s76, 107776
  v_add_u32 v46, s73, v46
  ds_read_u16 v50, v46
  v_lshl_add_u32 v45, v47, 10, v45
  v_lshlrev_b32 v51, 4, v47
  v_add_u32 v51, 107008, v51
  s_waitcnt lgkmcnt(0)
  v_lshlrev_b32 v100, 16, v96
  v_and_b32 v101, 0xffff0000, v96
L_w_mk_12:
  s_cbranch_execz L_w_mk_13
  v_lshlrev_b32 v102, 16, v97
  v_and_b32 v103, 0xffff0000, v97
  v_lshlrev_b32 v104, 16, v98
  v_and_b32 v105, 0xffff0000, v98
  v_lshlrev_b32 v106, 16, v99
  v_and_b32 v107, 0xffff0000, v99
  v_readfirstlane_b32 s68, v100
  s_nop 1
  v_subrev_f32 v108, s68, v100
  v_subrev_f32 v109, s68, v101
  v_subrev_f32 v110, s68, v102
  v_subrev_f32 v111, s68, v103
L_w_mk_13:
  s_cbranch_execz L_w_mk_14
  v_subrev_f32 v112, s68, v104
  v_subrev_f32 v113, s68, v105
  v_subrev_f32 v114, s68, v106
  v_subrev_f32 v115, s68, v107
  v_add_f32 v116, v108, v109
  v_mul_f32 v117, v108, v108
  v_fmac_f32 v117, v109, v109
  v_add_f32 v116, v116, v110
  v_fmac_f32 v117, v110, v110
  v_add_f32 v116, v116, v111
  v_fmac_f32 v117, v111, v111
  v_add_f32 v116, v116, v112
  v_fmac_f32 v117, v112, v112
  v_add_f32 v116, v116, v113
  v_fmac_f32 v117, v113, v113
L_w_mk_14:
  s_cbranch_execz L_w_mk_15
  v_add_f32 v116, v116, v114
  v_fmac_f32 v117, v114, v114
  v_add_f32 v116, v116, v115
  v_fmac_f32 v117, v115, v115
  s_nop 0
  v_add_f32_dpp v116, v116, v116 row_shr:1 row_mask:0xf bank_mask:0xf
  v_add_f32_dpp v117, v117, v117 row_shr:1 row_mask:0xf bank_mask:0xf
  s_nop 0
  v_add_f32_dpp v116, v116, v116 row_shr:2 row_mask:0xf bank_mask:0xf
  v_add_f32_dpp v117, v117, v117 row_shr:2 row_mask:0xf bank_mask:0xf
  s_nop 0
L_w_mk_15:
  s_cbranch_execz L_w_mk_16
  v_add_f32_dpp v116, v116, v116 row_shr:4 row_mask:0xf bank_mask:0xf
  v_add_f32_dpp v117, v117, v117 row_shr:4 row_mask:0xf bank_mask:0xf
  s_nop 0
  v_add_f32_dpp v116, v116, v116 row_shr:8 row_mask:0xf bank_mask:0xf
  v_add_f32_dpp v117, v117, v117 row_shr:8 row_mask:0xf bank_mask:0xf
  s_nop 0
  v_add_f32_dpp v116, v116, v116 row_bcast:15 row_mask:0xa bank_mask:0xf
  v_add_f32_dpp v117, v117, v117 row_bcast:15 row_mask:0xa bank_mask:0xf
  s_nop 0
L_w_mk_16:
  s_cbranch_execz L_w_mk_17
  v_add_f32_dpp v116, v116, v116 row_bcast:31 row_mask:0xc bank_mask:0xf
  v_add_f32_dpp v117, v117, v117 row_bcast:31 row_mask:0xc bank_mask:0xf
  v_readlane_b32 s69, v116, 63
  v_readlane_b32 s70, v117, 63
  s_nop 0
  v_mov_b32 v124, s69
  v_mov_b32 v125, s70
  v_mul_f32 v124, 0x3b000000, v124
  v_mul_f32 v125, 0x3b000000, v125
L_w_mk_17:
  s_cbranch_execz L_w_mk_18
  v_fma_f32 v125, -v124, v124, v125
  v_add_f32 v124, s68, v124
  v_max_f32 v125, 0, v125
  v_cvt_pk_bf16_f32 v108, v124, v125
  v_lshlrev_b32 v124, 16, v108
  v_and_b32 v125, 0xffff0000, v108
  v_add_f32 v125, 0x3727c5ac, v125
  v_cvt_pk_bf16_f32 v125, v125, v125
  v_lshlrev_b32 v125, 16, v125
  v_sqrt_f32 v125, v125
L_w_mk_18:
  s_cbranch_execz L_w_mk_19
  s_nop 0
  v_cvt_pk_bf16_f32 v125, v125, v125
  v_lshlrev_b32 v125, 16, v125
  v_rcp_f32 v125, v125
  v_sub_f32 v108, v100, v124
  v_sub_f32 v109, v101, v124
  v_sub_f32 v110, v102, v124
  v_sub_f32 v111, v103, v124
  v_sub_f32 v112, v104, v124
  v_sub_f32 v113, v105, v124
  v_sub_f32 v114, v106, v124
  v_sub_f32 v115, v107, v124
  v_cvt_pk_bf16_f32 v109, v108, v109
L_w_mk_19:
  s_cbranch_execz L_w_mk_20
  v_cvt_pk_bf16_f32 v111, v110, v111
  v_cvt_pk_bf16_f32 v113, v112, v113
  v_cvt_pk_bf16_f32 v115, v114, v115
  v_lshlrev_b32 v108, 16, v109
  v_and_b32 v109, 0xffff0000, v109
  v_lshlrev_b32 v110, 16, v111
  v_and_b32 v111, 0xffff0000, v111
  v_lshlrev_b32 v112, 16, v113
  v_and_b32 v113, 0xffff0000, v113
L_w_mk_20:
  s_cbranch_execz L_w_mk_21
  v_lshlrev_b32 v114, 16, v115
  v_and_b32 v115, 0xffff0000, v115
  v_mul_f32 v108, v108, v125
  v_mul_f32 v109, v109, v125
  v_mul_f32 v110, v110, v125
  v_mul_f32 v111, v111, v125
  v_mul_f32 v112, v112, v125
  v_mul_f32 v113, v113, v125
  v_mul_f32 v114, v114, v125
  v_mul_f32 v115, v115, v125
  v_cvt_pk_bf16_f32 v120, v108, v109
  v_cvt_pk_bf16_f32 v121, v110, v111
L_w_mk_21:
  s_cbranch_execz L_wret
  v_cvt_pk_bf16_f32 v122, v112, v113
  v_cvt_pk_bf16_f32 v123, v114, v115
L_w_mk2_0:
  s_cbranch_execz L_w_mk2_1
  v_mov_b32 v126, 0
  v_dot2c_f32_bf16 v126, v120, v32
  v_dot2c_f32_bf16 v126, v121, v33
  v_dot2c_f32_bf16 v126, v122, v34
  v_dot2c_f32_bf16 v126, v123, v35
  s_nop 2
  v_add_f32_dpp v126, v126, v126 row_shr:1 row_mask:0xf bank_mask:0xf
  s_nop 1
  v_add_f32_dpp v126, v126, v126 row_shr:2 row_mask:0xf bank_mask:0xf
L_w_mk2_1:
  s_cbranch_execz L_w_mk2_2
  s_nop 1
  v_add_f32_dpp v126, v126, v126 row_shr:4 row_mask:0xf bank_mask:0xf
  s_nop 1
  v_add_f32_dpp v126, v126, v126 row_shr:8 row_mask:0xf bank_mask:0xf
  s_nop 1
  v_add_f32_dpp v126, v126, v126 row_bcast:15 row_mask:0xa bank_mask:0xf
  s_nop 1
  v_add_f32_dpp v126, v126, v126 row_bcast:31 row_mask:0xc bank_mask:0xf
  s_nop 0
  v_readlane_b32 s73, v126, 63
L_w_mk2_2:
  s_cbranch_execz L_w_mk2_3
  s_nop 1
  v_mov_b32 v126, s73
  v_cvt_pk_bf16_f32 v126, v126, v126
  v_lshlrev_b32 v126, 16, v126
  v_mul_f32 v126, 0xbfb8aa3b, v126
  v_exp_f32 v126, v126
  s_nop 0
  v_add_f32 v126, 1.0, v126
  v_rcp_f32 v126, v126
  s_nop 0
  v_cvt_pk_bf16_f32 v126, v126, v126
L_w_mk2_3:
  s_cbranch_execz L_w_mk2_4
  v_lshlrev_b32 v126, 16, v126
  v_mov_b32 v127, 0
  s_lshl_b32 s73, s3, 4
  s_add_u32 s73, s73, 107008
  v_mov_b32 v46, s73
  ds_write_b128 v46, v[124:127]
  v_lshlrev_b32 v104, 16, v50
  v_mov_b32 v20, 0
  v_mov_b32 v21, 0
  v_mov_b32 v22, 0
  v_mov_b32 v23, 0
  s_mov_b32 s75, 1000000
L_pS:
L_w_mk2_4:
  s_cbranch_execz L_w_mk2_5
  ds_read_b128 v[112:115], v51
  s_sub_u32 s75, s75, 1
  s_cbranch_scc1 L_pS_ok
  s_waitcnt lgkmcnt(0)
  v_max3_u32 v47, v112, v113, v114
  v_cmp_eq_u32 vcc, -1, v47
  s_cbranch_vccnz L_pS
L_pS_ok:
  v_sub_f32 v100, v104, v112
  v_cvt_pk_bf16_f32 v100, v100, v100
  v_lshlrev_b32 v100, 16, v100
  v_mul_f32 v100, v100, v113
  v_cvt_pk_bf16_f32 v100, v100, v100
L_w_mk2_5:
  s_cbranch_execz L_w_mk2_6
  v_lshlrev_b32 v100, 16, v100
  v_add_f32 v100, v100, v104
  v_and_b32 v46, 31, v0
  v_lshlrev_b32 v46, 2, v46
  v_add_u32 v46, 106880, v46
  s_mov_b32 s75, 1000000
L_pT:
  ds_read_b32 v47, v46 offset:0
  s_sub_u32 s75, s75, 1
  s_cbranch_scc1 L_pT_ok
  s_waitcnt lgkmcnt(0)
  v_cmp_eq_u32 vcc, -1, v47
L_w_mk2_6:
  s_cbranch_execz L_w_mk2_7
  s_cbranch_vccnz L_pT
L_pT_ok:
  s_mov_b32 s75, 1000000
L_pC:
  buffer_load_dwordx4 v[12:15], v44, s[24:27], s78 offen sc1
  buffer_load_dwordx4 v[16:19], v44, s[24:27], s79 offen sc1
  s_mov_b32 exec_hi, 0xfff
  buffer_load_dwordx4 v[20:23], v44, s[24:27], s77 offen sc1
  s_waitcnt vmcnt(0)
  v_xor_b32 v20, s60, v20
  v_xor_b32 v21, s61, v21
  v_xor_b32 v22, s62, v22
L_w_mk2_7:
  s_cbranch_execz L_w_mk2_8
  v_xor_b32 v23, s63, v23
  s_mov_b64 exec, -1
  s_sub_u32 s75, s75, 1
  s_cbranch_scc1 L_pC_ok
  v_xor_b32 v12, s60, v12
  v_xor_b32 v13, s61, v13
  v_xor_b32 v14, s62, v14
  v_xor_b32 v15, s63, v15
  v_xor_b32 v16, s60, v16
  v_xor_b32 v17, s61, v17
  v_xor_b32 v18, s62, v18
  v_xor_b32 v19, s63, v19
  v_or3_b32 v24, v12, v13, v14
  v_or3_b32 v24, v24, v15, v16
L_w_mk2_8:
  s_cbranch_execz L_w_mk2_9
  v_or3_b32 v24, v24, v17, v18
  v_or3_b32 v24, v24, v19, v20
  v_or3_b32 v24, v24, v21, v22
  v_or_b32 v24, v24, v23
  v_and_b32 v24, 0xff, v24
  v_cmp_ne_u32 vcc, 0, v24
  s_cbranch_vccnz L_pC
L_pC_ok:
  v_add_f32 v12, v12, v16
  v_add_f32 v13, v13, v17
  v_add_f32 v14, v14, v18
L_w_mk2_9:
  s_cbranch_execz L_w_mk2_10
  v_add_f32 v15, v15, v19
  v_add_f32 v12, v12, v20
  v_add_f32 v13, v13, v21
  v_add_f32 v14, v14, v22
  v_add_f32 v15, v15, v23
  s_nop 0
  v_permlane32_swap_b32 v12, v14
  v_permlane32_swap_b32 v13, v15
  v_add_f32 v12, v12, v14
  v_add_f32 v13, v13, v15
  s_nop 1
  v_permlane16_swap_b32 v12, v13
  v_add_f32 v12, v12, v13
  s_nop 1
  v_add_f32_dpp v12, v12, v12 row_ror:4 row_mask:0xf bank_mask:0xf
L_w_mk2_10:
  s_cbranch_execz L_w_mk2_11
  s_nop 1
  v_add_f32_dpp v12, v12, v12 row_ror:8 row_mask:0xf bank_mask:0xf
  v_fmac_f32 v100, v12, v114
  v_cvt_pk_bf16_f32 v12, v100, v100
  s_mov_b32 exec_lo, 0x000f000f
  s_mov_b32 exec_hi, 0x000f000f
  buffer_store_short v12, v45, s[48:51], s76 offen
  s_cmp_lg_u32 s76, 0
  s_cbranch_scc1 L_noep
L_w_mk2_11:
  s_cbranch_execz L_wret
  s_mov_b64 exec, 1
  v_mov_b32 v14, s29
  buffer_store_dword v14, v45, s[24:27], 0 offen
L_noep:
  s_mov_b64 exec, -1
  s_branch L_fin
L_aux:
  s_sub_u32 s59, s3, 8
  s_and_b32 s55, s2, 31
  s_bfe_u32 s56, s2, 0x10005
  v_lshrrev_b32 v2, 4, v0
  v_and_b32 v3, 15, v0
  s_mov_b32 s10, 0x400000
  s_mov_b32 s11, 0x20000
  v_lshlrev_b32 v8, 18, v2
  v_lshl_or_b32 v8, v3, 4, v8
  s_lshl_b32 s54, s59, 20
  s_lshl_b32 s53, s55, 8
  s_or_b32 s54, s54, s53
  v_lshlrev_b32 v10, 6, v2
  s_lshl_b32 s52, s56, 10
  s_lshl_b32 s53, s59, 8
  s_add_u32 s53, s53, s52
  s_movk_i32 s65, 0x2000
  v_mov_b32 v12, -1
  v_mov_b32 v13, -1
  v_mov_b32 v14, -1
  v_mov_b32 v15, -1
  s_lshl_b32 s58, s59, 11
  s_add_u32 s58, s58, 100352
  v_add_u32 v9, s58, v1
  ds_write_b128 v9, v[12:15]
  s_cmp_eq_u32 s59, 3
  s_cbranch_scc0 L_i2
  v_mov_b32 v12, 0
  v_mov_b32 v13, 0
  v_mov_b32 v14, 0
  v_mov_b32 v15, 0
  s_mov_b64 exec, 1
L_i2:
  ds_write_b128 v9, v[12:15] offset:1024
  s_mov_b64 exec, -1
  s_waitcnt lgkmcnt(0)
  s_load_dword s28, s[24:25], 0
  s_cmp_eq_u32 s59, 0
  s_cbranch_scc1 L_coop
  s_barrier
  v_mov_b32 v12, 106496
  s_waitcnt lgkmcnt(0)
  s_and_b32 s29, s28, 0x7f7f7f7f
  s_add_u32 s29, s29, 0x07050301
  s_and_b32 s30, s28, 0x80808080
  s_xor_b32 s29, s29, s30
  s_bfe_u32 s60, s29, 0x80000
  s_bfe_u32 s61, s29, 0x80008
  s_bfe_u32 s62, s29, 0x80010
  s_bfe_u32 s63, s29, 0x80018
  s_mov_b32 s31, 0xffffff00
  s_mov_b32 s75, 1000000
L_fw:
  s_sleep 4
  ds_read2_b32 v[14:15], v12 offset0:0 offset1:144
  s_sub_u32 s75, s75, 1
  s_cbranch_scc1 L_fw_ok
  s_waitcnt lgkmcnt(0)
  v_cmp_ne_u32 vcc, -1, v15
  s_cbranch_vccnz L_fallback
  v_cmp_eq_u32 vcc, -1, v14
  s_cbranch_vccnz L_fw
L_fw_ok:
  s_mov_b64 exec, 0
  s_cmp_eq_u32 s59, 1
  s_cbranch_scc1 L_w_ct_0
L_wret1:
  s_cmp_lt_u32 s2, 43
  s_cbranch_scc1 L_wm
  s_cmp_lg_u32 s57, 1
  s_cbranch_scc1 L_wret
  s_cmp_eq_u32 s59, 2
  s_cbranch_scc1 L_w_rk_0
  s_cmp_eq_u32 s59, 3
  s_cbranch_scc1 L_w_ra_0
  s_branch L_wret
L_wm:
  s_cmp_eq_u32 s59, 1
  s_cbranch_scc1 L_w_ma_0
  s_cmp_eq_u32 s59, 2
  s_cbranch_scc1 L_w_mk_0
  s_branch L_w_mk2_0
L_wret:
  s_mov_b64 exec, -1
  s_branch L_aux4
L_coop:
  s_lshl_b32 s58, s56, 2
  s_add_u32 s58, s58, s57
  v_lshlrev_b32 v40, 17, v2
  v_lshl_or_b32 v40, v3, 4, v40
  s_lshl_b32 s71, s58, 19
  s_lshl_b32 s72, s55, 8
  s_or_b32 s71, s71, s72
  v_lshrrev_b32 v41, 3, v3
  v_lshlrev_b32 v42, 10, v41
  v_lshl_add_u32 v42, v2, 5, v42
  s_lshl_b32 s72, s58, 7
  buffer_load_dwordx4 v[44:47], v1, s[4:7], 0 offen
  buffer_load_dwordx4 v[48:51], v1, s[4:7], 0 offen offset:1024
  buffer_load_dwordx4 v[52:55], v42, s[4:7], s72 offen
  buffer_load_dwordx4 v[56:59], v42, s[4:7], s72 offen offset:16
  buffer_load_dwordx4 v[72:75], v40, s[8:11], s71 offen
  s_add_u32 s71, s71, s65
  buffer_load_dwordx4 v[76:79], v40, s[8:11], s71 offen
  s_add_u32 s71, s71, s65
  buffer_load_dwordx4 v[80:83], v40, s[8:11], s71 offen
  s_add_u32 s71, s71, s65
  buffer_load_dwordx4 v[84:87], v40, s[8:11], s71 offen
  s_add_u32 s71, s71, s65
  buffer_load_dwordx4 v[88:91], v40, s[8:11], s71 offen
  s_add_u32 s71, s71, s65
  buffer_load_dwordx4 v[92:95], v40, s[8:11], s71 offen
  s_add_u32 s71, s71, s65
  buffer_load_dwordx4 v[96:99], v40, s[8:11], s71 offen
  s_add_u32 s71, s71, s65
  buffer_load_dwordx4 v[100:103], v40, s[8:11], s71 offen
  s_add_u32 s71, s71, s65
  buffer_load_dwordx4 v[104:107], v40, s[8:11], s71 offen
  s_add_u32 s71, s71, s65
  buffer_load_dwordx4 v[108:111], v40, s[8:11], s71 offen
  s_add_u32 s71, s71, s65
  buffer_load_dwordx4 v[112:115], v40, s[8:11], s71 offen
  s_add_u32 s71, s71, s65
  buffer_load_dwordx4 v[116:119], v40, s[8:11], s71 offen
  s_add_u32 s71, s71, s65
  buffer_load_dwordx4 v[120:123], v40, s[8:11], s71 offen
  s_add_u32 s71, s71, s65
  buffer_load_dwordx4 v[124:127], v40, s[8:11], s71 offen
  s_add_u32 s71, s71, s65
  buffer_load_dwordx4 v[128:131], v40, s[8:11], s71 offen
  s_add_u32 s71, s71, s65
  buffer_load_dwordx4 v[132:135], v40, s[8:11], s71 offen
  s_barrier
  v_and_b32 v12, 1, v0
  v_lshlrev_b32 v12, 4, v12
  v_mov_b32 v13, 0xffff
  v_lshlrev_b32 v12, v12, v13
  v_bfe_u32 v13, v0, 1, 2
  v_cmp_eq_u32 vcc, 0, v13
  s_nop 1
  v_cndmask_b32 v4, 0, v12, vcc
  v_cmp_eq_u32 vcc, 1, v13
  s_nop 1
  v_cndmask_b32 v5, 0, v12, vcc
  v_cmp_eq_u32 vcc, 2, v13
  s_nop 1
  v_cndmask_b32 v6, 0, v12, vcc
  v_cmp_eq_u32 vcc, 3, v13
  s_nop 1
  v_cndmask_b32 v7, 0, v12, vcc
  v_cmp_eq_u32 s[66:67], 1, v41
  s_waitcnt vmcnt(18) lgkmcnt(0)
  s_and_b32 s29, s28, 0x7f7f7f7f
  s_add_u32 s29, s29, 0x07050301
  s_and_b32 s30, s28, 0x80808080
  s_xor_b32 s29, s29, s30
  s_bfe_u32 s60, s29, 0x80000
  s_bfe_u32 s61, s29, 0x80008
  s_bfe_u32 s62, s29, 0x80010
  s_bfe_u32 s63, s29, 0x80018
  s_mov_b32 s31, 0xffffff00
  v_lshlrev_b32 v24, 16, v44
  v_and_b32 v25, 0xffff0000, v44
  v_lshlrev_b32 v26, 16, v45
  v_and_b32 v27, 0xffff0000, v45
  v_lshlrev_b32 v28, 16, v46
  v_and_b32 v29, 0xffff0000, v46
  v_lshlrev_b32 v30, 16, v47
  v_and_b32 v31, 0xffff0000, v47
  v_lshlrev_b32 v60, 16, v48
  v_and_b32 v61, 0xffff0000, v48
  v_lshlrev_b32 v62, 16, v49
  v_and_b32 v63, 0xffff0000, v49
  v_lshlrev_b32 v64, 16, v50
  v_and_b32 v65, 0xffff0000, v50
  v_lshlrev_b32 v66, 16, v51
  v_and_b32 v67, 0xffff0000, v51
  v_readfirstlane_b32 s68, v24
  v_readfirstlane_b32 s76, v60
  s_nop 0
  v_subrev_f32 v12, s68, v24
  v_subrev_f32 v32, s76, v60
  v_subrev_f32 v13, s68, v25
  v_subrev_f32 v33, s76, v61
  v_subrev_f32 v14, s68, v26
  v_subrev_f32 v34, s76, v62
  v_subrev_f32 v15, s68, v27
  v_subrev_f32 v35, s76, v63
  v_subrev_f32 v16, s68, v28
  v_subrev_f32 v36, s76, v64
  v_subrev_f32 v17, s68, v29
  v_subrev_f32 v37, s76, v65
  v_subrev_f32 v18, s68, v30
  v_subrev_f32 v38, s76, v66
  v_subrev_f32 v19, s68, v31
  v_subrev_f32 v39, s76, v67
  v_add_f32 v20, v12, v13
  v_add_f32 v40, v32, v33
  v_mul_f32 v21, v12, v12
  v_mul_f32 v41, v32, v32
  v_fmac_f32 v21, v13, v13
  v_fmac_f32 v41, v33, v33
  v_add_f32 v20, v20, v14
  v_add_f32 v40, v40, v34
  v_fmac_f32 v21, v14, v14
  v_fmac_f32 v41, v34, v34
  v_add_f32 v20, v20, v15
  v_add_f32 v40, v40, v35
  v_fmac_f32 v21, v15, v15
  v_fmac_f32 v41, v35, v35
  v_add_f32 v20, v20, v16
  v_add_f32 v40, v40, v36
  v_fmac_f32 v21, v16, v16
  v_fmac_f32 v41, v36, v36
  v_add_f32 v20, v20, v17
  v_add_f32 v40, v40, v37
  v_fmac_f32 v21, v17, v17
  v_fmac_f32 v41, v37, v37
  v_add_f32 v20, v20, v18
  v_add_f32 v40, v40, v38
  v_fmac_f32 v21, v18, v18
  v_fmac_f32 v41, v38, v38
  v_add_f32 v20, v20, v19
  v_add_f32 v40, v40, v39
  v_fmac_f32 v21, v19, v19
  v_fmac_f32 v41, v39, v39
  v_add_f32_dpp v20, v20, v20 row_shr:1 row_mask:0xf bank_mask:0xf
  v_add_f32_dpp v40, v40, v40 row_shr:1 row_mask:0xf bank_mask:0xf
  v_add_f32_dpp v21, v21, v21 row_shr:1 row_mask:0xf bank_mask:0xf
  v_add_f32_dpp v41, v41, v41 row_shr:1 row_mask:0xf bank_mask:0xf
  v_add_f32_dpp v20, v20, v20 row_shr:2 row_mask:0xf bank_mask:0xf
  v_add_f32_dpp v40, v40, v40 row_shr:2 row_mask:0xf bank_mask:0xf
  v_add_f32_dpp v21, v21, v21 row_shr:2 row_mask:0xf bank_mask:0xf
  v_add_f32_dpp v41, v41, v41 row_shr:2 row_mask:0xf bank_mask:0xf
  v_add_f32_dpp v20, v20, v20 row_shr:4 row_mask:0xf bank_mask:0xf
  v_add_f32_dpp v40, v40, v40 row_shr:4 row_mask:0xf bank_mask:0xf
  v_add_f32_dpp v21, v21, v21 row_shr:4 row_mask:0xf bank_mask:0xf
  v_add_f32_dpp v41, v41, v41 row_shr:4 row_mask:0xf bank_mask:0xf
  v_add_f32_dpp v20, v20, v20 row_shr:8 row_mask:0xf bank_mask:0xf
  v_add_f32_dpp v40, v40, v40 row_shr:8 row_mask:0xf bank_mask:0xf
  v_add_f32_dpp v21, v21, v21 row_shr:8 row_mask:0xf bank_mask:0xf
  v_add_f32_dpp v41, v41, v41 row_shr:8 row_mask:0xf bank_mask:0xf
  v_add_f32_dpp v20, v20, v20 row_bcast:15 row_mask:0xa bank_mask:0xf
  v_add_f32_dpp v40, v40, v40 row_bcast:15 row_mask:0xa bank_mask:0xf
  v_add_f32_dpp v21, v21, v21 row_bcast:15 row_mask:0xa bank_mask:0xf
  v_add_f32_dpp v41, v41, v41 row_bcast:15 row_mask:0xa bank_mask:0xf
  v_add_f32_dpp v20, v20, v20 row_bcast:31 row_mask:0xc bank_mask:0xf
  v_add_f32_dpp v40, v40, v40 row_bcast:31 row_mask:0xc bank_mask:0xf
  v_add_f32_dpp v21, v21, v21 row_bcast:31 row_mask:0xc bank_mask:0xf
  v_add_f32_dpp v41, v41, v41 row_bcast:31 row_mask:0xc bank_mask:0xf
  v_readlane_b32 s69, v20, 63
  v_readlane_b32 s77, v40, 63
  v_readlane_b32 s70, v21, 63
  v_readlane_b32 s78, v41, 63
  v_mov_b32 v60, s68
  v_mov_b32 v63, s76
  v_cndmask_b32 v60, v60, v63, s[66:67]
  v_mov_b32 v61, s69
  v_mov_b32 v63, s77
  v_cndmask_b32 v61, v61, v63, s[66:67]
  v_mov_b32 v62, s70
  v_mov_b32 v63, s78
  v_cndmask_b32 v62, v62, v63, s[66:67]
  v_mul_f32 v61, 0x3b000000, v61
  v_mul_f32 v62, 0x3b000000, v62
  v_fma_f32 v62, -v61, v61, v62
  v_add_f32 v61, v60, v61
  v_max_f32 v62, 0, v62
  v_cvt_pk_bf16_f32 v63, v61, v62
  v_lshlrev_b32 v61, 16, v63
  v_and_b32 v62, 0xffff0000, v63
  v_add_f32 v62, 0x3727c5ac, v62
  v_cvt_pk_bf16_f32 v62, v62, v62
  v_lshlrev_b32 v62, 16, v62
  v_sqrt_f32 v62, v62
  s_nop 0
  v_cvt_pk_bf16_f32 v62, v62, v62
  v_lshlrev_b32 v62, 16, v62
  v_rcp_f32 v62, v62
  s_waitcnt vmcnt(16)
  v_lshlrev_b32 v24, 16, v52
  v_and_b32 v25, 0xffff0000, v52
  v_lshlrev_b32 v26, 16, v53
  v_and_b32 v27, 0xffff0000, v53
  v_lshlrev_b32 v28, 16, v54
  v_and_b32 v29, 0xffff0000, v54
  v_lshlrev_b32 v30, 16, v55
  v_and_b32 v31, 0xffff0000, v55
  v_lshlrev_b32 v32, 16, v56
  v_and_b32 v33, 0xffff0000, v56
  v_lshlrev_b32 v34, 16, v57
  v_and_b32 v35, 0xffff0000, v57
  v_lshlrev_b32 v36, 16, v58
  v_and_b32 v37, 0xffff0000, v58
  v_lshlrev_b32 v38, 16, v59
  v_and_b32 v39, 0xffff0000, v59
  v_sub_f32 v24, v24, v61
  v_sub_f32 v25, v25, v61
  v_sub_f32 v26, v26, v61
  v_sub_f32 v27, v27, v61
  v_sub_f32 v28, v28, v61
  v_sub_f32 v29, v29, v61
  v_sub_f32 v30, v30, v61
  v_sub_f32 v31, v31, v61
  v_sub_f32 v32, v32, v61
  v_sub_f32 v33, v33, v61
  v_sub_f32 v34, v34, v61
  v_sub_f32 v35, v35, v61
  v_sub_f32 v36, v36, v61
  v_sub_f32 v37, v37, v61
  v_sub_f32 v38, v38, v61
  v_sub_f32 v39, v39, v61
  v_cvt_pk_bf16_f32 v25, v24, v25
  v_cvt_pk_bf16_f32 v27, v26, v27
  v_cvt_pk_bf16_f32 v29, v28, v29
  v_cvt_pk_bf16_f32 v31, v30, v31
  v_cvt_pk_bf16_f32 v33, v32, v33
  v_cvt_pk_bf16_f32 v35, v34, v35
  v_cvt_pk_bf16_f32 v37, v36, v37
  v_cvt_pk_bf16_f32 v39, v38, v39
  v_lshlrev_b32 v24, 16, v25
  v_and_b32 v25, 0xffff0000, v25
  v_lshlrev_b32 v26, 16, v27
  v_and_b32 v27, 0xffff0000, v27
  v_lshlrev_b32 v28, 16, v29
  v_and_b32 v29, 0xffff0000, v29
  v_lshlrev_b32 v30, 16, v31
  v_and_b32 v31, 0xffff0000, v31
  v_lshlrev_b32 v32, 16, v33
  v_and_b32 v33, 0xffff0000, v33
  v_lshlrev_b32 v34, 16, v35
  v_and_b32 v35, 0xffff0000, v35
  v_lshlrev_b32 v36, 16, v37
  v_and_b32 v37, 0xffff0000, v37
  v_lshlrev_b32 v38, 16, v39
  v_and_b32 v39, 0xffff0000, v39
  v_mul_f32 v24, v24, v62
  v_mul_f32 v25, v25, v62
  v_mul_f32 v26, v26, v62
  v_mul_f32 v27, v27, v62
  v_mul_f32 v28, v28, v62
  v_mul_f32 v29, v29, v62
  v_mul_f32 v30, v30, v62
  v_mul_f32 v31, v31, v62
  v_mul_f32 v32, v32, v62
  v_mul_f32 v33, v33, v62
  v_mul_f32 v34, v34, v62
  v_mul_f32 v35, v35, v62
  v_mul_f32 v36, v36, v62
  v_mul_f32 v37, v37, v62
  v_mul_f32 v38, v38, v62
  v_mul_f32 v39, v39, v62
  v_cvt_pk_bf16_f32 v24, v24, v24
  v_cvt_pk_bf16_f32 v25, v25, v25
  v_cvt_pk_bf16_f32 v26, v26, v26
  v_cvt_pk_bf16_f32 v27, v27, v27
  v_cvt_pk_bf16_f32 v28, v28, v28
  v_cvt_pk_bf16_f32 v29, v29, v29
  v_cvt_pk_bf16_f32 v30, v30, v30
  v_cvt_pk_bf16_f32 v31, v31, v31
  v_cvt_pk_bf16_f32 v32, v32, v32
  v_cvt_pk_bf16_f32 v33, v33, v33
  v_cvt_pk_bf16_f32 v34, v34, v34
  v_cvt_pk_bf16_f32 v35, v35, v35
  v_cvt_pk_bf16_f32 v36, v36, v36
  v_cvt_pk_bf16_f32 v37, v37, v37
  v_cvt_pk_bf16_f32 v38, v38, v38
  v_cvt_pk_bf16_f32 v39, v39, v39
  v_and_b32 v12, v24, v4
  v_and_b32 v13, v24, v5
  v_and_b32 v14, v24, v6
  v_and_b32 v15, v24, v7
  s_waitcnt vmcnt(15)
  s_nop 0
  v_mfma_f32_16x16x32_bf16 v[20:23], v[12:15], v[72:75], 0
  v_and_b32 v16, v25, v4
  v_and_b32 v17, v25, v5
  v_and_b32 v18, v25, v6
  v_and_b32 v19, v25, v7
  s_waitcnt vmcnt(14)
  s_nop 0
  v_mfma_f32_16x16x32_bf16 v[20:23], v[16:19], v[76:79], v[20:23]
  v_and_b32 v12, v26, v4
  v_and_b32 v13, v26, v5
  v_and_b32 v14, v26, v6
  v_and_b32 v15, v26, v7
  s_waitcnt vmcnt(13)
  s_nop 0
  v_mfma_f32_16x16x32_bf16 v[20:23], v[12:15], v[80:83], v[20:23]
  v_and_b32 v16, v27, v4
  v_and_b32 v17, v27, v5
  v_and_b32 v18, v27, v6
  v_and_b32 v19, v27, v7
  s_waitcnt vmcnt(12)
  s_nop 0
  v_mfma_f32_16x16x32_bf16 v[20:23], v[16:19], v[84:87], v[20:23]
  v_and_b32 v12, v28, v4
  v_and_b32 v13, v28, v5
  v_and_b32 v14, v28, v6
  v_and_b32 v15, v28, v7
  s_waitcnt vmcnt(11)
  s_nop 0
  v_mfma_f32_16x16x32_bf16 v[20:23], v[12:15], v[88:91], v[20:23]
  v_and_b32 v16, v29, v4
  v_and_b32 v17, v29, v5
  v_and_b32 v18, v29, v6
  v_and_b32 v19, v29, v7
  s_waitcnt vmcnt(10)
  s_nop 0
  v_mfma_f32_16x16x32_bf16 v[20:23], v[16:19], v[92:95], v[20:23]
  v_and_b32 v12, v30, v4
  v_and_b32 v13, v30, v5
  v_and_b32 v14, v30, v6
  v_and_b32 v15, v30, v7
  s_waitcnt vmcnt(9)
  s_nop 0
  v_mfma_f32_16x16x32_bf16 v[20:23], v[12:15], v[96:99], v[20:23]
  v_and_b32 v16, v31, v4
  v_and_b32 v17, v31, v5
  v_and_b32 v18, v31, v6
  v_and_b32 v19, v31, v7
  s_waitcnt vmcnt(8)
  s_nop 0
  v_mfma_f32_16x16x32_bf16 v[20:23], v[16:19], v[100:103], v[20:23]
  v_and_b32 v12, v32, v4
  v_and_b32 v13, v32, v5
  v_and_b32 v14, v32, v6
  v_and_b32 v15, v32, v7
  s_waitcnt vmcnt(7)
  s_nop 0
  v_mfma_f32_16x16x32_bf16 v[20:23], v[12:15], v[104:107], v[20:23]
  v_and_b32 v16, v33, v4
  v_and_b32 v17, v33, v5
  v_and_b32 v18, v33, v6
  v_and_b32 v19, v33, v7
  s_waitcnt vmcnt(6)
  s_nop 0
  v_mfma_f32_16x16x32_bf16 v[20:23], v[16:19], v[108:111], v[20:23]
  v_and_b32 v12, v34, v4
  v_and_b32 v13, v34, v5
  v_and_b32 v14, v34, v6
  v_and_b32 v15, v34, v7
  s_waitcnt vmcnt(5)
  s_nop 0
  v_mfma_f32_16x16x32_bf16 v[20:23], v[12:15], v[112:115], v[20:23]
  v_and_b32 v16, v35, v4
  v_and_b32 v17, v35, v5
  v_and_b32 v18, v35, v6
  v_and_b32 v19, v35, v7
  s_waitcnt vmcnt(4)
  s_nop 0
  v_mfma_f32_16x16x32_bf16 v[20:23], v[16:19], v[116:119], v[20:23]
  v_and_b32 v12, v36, v4
  v_and_b32 v13, v36, v5
  v_and_b32 v14, v36, v6
  v_and_b32 v15, v36, v7
  s_waitcnt vmcnt(3)
  s_nop 0
  v_mfma_f32_16x16x32_bf16 v[20:23], v[12:15], v[120:123], v[20:23]
  v_and_b32 v16, v37, v4
  v_and_b32 v17, v37, v5
  v_and_b32 v18, v37, v6
  v_and_b32 v19, v37, v7
  s_waitcnt vmcnt(2)
  s_nop 0
  v_mfma_f32_16x16x32_bf16 v[20:23], v[16:19], v[124:127], v[20:23]
  v_and_b32 v12, v38, v4
  v_and_b32 v13, v38, v5
  v_and_b32 v14, v38, v6
  v_and_b32 v15, v38, v7
  s_waitcnt vmcnt(1)
  s_nop 0
  v_mfma_f32_16x16x32_bf16 v[20:23], v[12:15], v[128:131], v[20:23]
  v_and_b32 v16, v39, v4
  v_and_b32 v17, v39, v5
  v_and_b32 v18, v39, v6
  v_and_b32 v19, v39, v7
  s_waitcnt vmcnt(0)
  s_nop 0
  v_mfma_f32_16x16x32_bf16 v[20:23], v[16:19], v[132:135], v[20:23]
  v_lshrrev_b32 v40, 5, v0
  v_lshlrev_b32 v42, 2, v40
  v_lshlrev_b32 v40, 13, v40
  v_and_b32 v41, 31, v0
  v_lshl_add_u32 v40, v41, 4, v40
  s_lshl_b32 s71, s55, 14
  s_add_u32 s71, s71, 331776
  s_lshl_b32 s72, s58, 10
  s_add_u32 s72, s72, s71
  v_mov_b32 v13, s29
  v_mov_b32 v15, s29
  v_mov_b32 v17, s29
  v_mov_b32 v19, s29
  v_mov_b32 v12, v20
  v_mov_b32 v14, v21
  v_mov_b32 v16, v22
  v_mov_b32 v18, v23
  buffer_store_dwordx4 v[12:15], v40, s[24:27], s72 offen
  buffer_store_dwordx4 v[16:19], v40, s[24:27], s72 offen offset:512
  s_lshl_b32 s72, s56, 13
  s_add_u32 s71, s71, s72
  s_add_u32 s72, s71, 4096
  v_and_b32 v41, 1, v2
  v_lshl_add_u32 v41, v41, 3, v42
  v_lshl_add_u32 v41, v3, 4, v41
  v_add_u32 v41, 106496, v41
  s_movk_i32 s75, 8
L_pX:
  s_sleep 12
  buffer_load_dwordx4 v[72:75], v1, s[24:27], s71 offen offset:0 sc1
  buffer_load_dwordx4 v[76:79], v1, s[24:27], s71 offen offset:1024 sc1
  buffer_load_dwordx4 v[80:83], v1, s[24:27], s71 offen offset:2048 sc1
  buffer_load_dwordx4 v[84:87], v1, s[24:27], s71 offen offset:3072 sc1
  buffer_load_dwordx4 v[88:91], v1, s[24:27], s72 offen offset:0 sc1
  buffer_load_dwordx4 v[92:95], v1, s[24:27], s72 offen offset:1024 sc1
  buffer_load_dwordx4 v[96:99], v1, s[24:27], s72 offen offset:2048 sc1
  buffer_load_dwordx4 v[100:103], v1, s[24:27], s72 offen offset:3072 sc1
  s_sub_u32 s75, s75, 1
  s_cbranch_scc1 L_giveup
  s_waitcnt vmcnt(0)
  v_xor_b32 v73, s29, v73
  v_xor_b32 v75, s29, v75
  v_xor_b32 v77, s29, v77
  v_xor_b32 v79, s29, v79
  v_xor_b32 v81, s29, v81
  v_xor_b32 v83, s29, v83
  v_xor_b32 v85, s29, v85
  v_xor_b32 v87, s29, v87
  v_xor_b32 v89, s29, v89
  v_xor_b32 v91, s29, v91
  v_xor_b32 v93, s29, v93
  v_xor_b32 v95, s29, v95
  v_xor_b32 v97, s29, v97
  v_xor_b32 v99, s29, v99
  v_xor_b32 v101, s29, v101
  v_xor_b32 v103, s29, v103
  v_or3_b32 v60, v73, v75, v77
  v_or3_b32 v60, v60, v79, v81
  v_or3_b32 v60, v60, v83, v85
  v_or3_b32 v60, v60, v87, v89
  v_or3_b32 v60, v60, v91, v93
  v_or3_b32 v60, v60, v95, v97
  v_or3_b32 v60, v60, v99, v101
  v_or_b32 v60, v60, v103
  v_cmp_ne_u32 vcc, 0, v60
  s_cbranch_vccnz L_pX
  v_add_f32 v72, v72, v76
  v_add_f32 v74, v74, v78
  v_add_f32 v72, v72, v80
  v_add_f32 v74, v74, v82
  v_add_f32 v72, v72, v84
  v_add_f32 v74, v74, v86
  v_add_f32 v72, v72, v88
  v_add_f32 v74, v74, v90
  v_add_f32 v72, v72, v92
  v_add_f32 v74, v74, v94
  v_add_f32 v72, v72, v96
  v_add_f32 v74, v74, v98
  v_add_f32 v72, v72, v100
  v_add_f32 v74, v74, v102
  v_cvt_pk_bf16_f32 v72, v72, v74
  ds_write_b32 v41, v72
  v_lshlrev_b32 v8, 3, v0
  v_add_u32 v11, 100352, v8
  s_branch L_qdone
L_giveup:
  v_mov_b32 v12, 107072
  v_mov_b32 v13, 1
  ds_write_b32 v12, v13
  s_waitcnt vmcnt(0)
L_fallback:
  buffer_load_dwordx4 v[20:23], v1, s[4:7], s52 offen
  buffer_load_dwordx4 v[56:59], v10, s[4:7], s53 offen offset:0
  buffer_load_dwordx4 v[60:63], v10, s[4:7], s53 offen offset:16
  buffer_load_dwordx4 v[64:67], v10, s[4:7], s53 offen offset:32
  buffer_load_dwordx4 v[68:71], v10, s[4:7], s53 offen offset:48
  buffer_load_dwordx4 v[72:75], v8, s[8:11], s54 offen
  s_add_u32 s54, s54, s65
  buffer_load_dwordx4 v[76:79], v8, s[8:11], s54 offen
  s_add_u32 s54, s54, s65
  buffer_load_dwordx4 v[80:83], v8, s[8:11], s54 offen
  s_add_u32 s54, s54, s65
  buffer_load_dwordx4 v[84:87], v8, s[8:11], s54 offen
  s_add_u32 s54, s54, s65
  buffer_load_dwordx4 v[88:91], v8, s[8:11], s54 offen
  s_add_u32 s54, s54, s65
  buffer_load_dwordx4 v[92:95], v8, s[8:11], s54 offen
  s_add_u32 s54, s54, s65
  s_waitcnt vmcnt(6)
  s_waitcnt vmcnt(5)
  buffer_load_dwordx4 v[96:99], v8, s[8:11], s54 offen
  s_add_u32 s54, s54, s65
  v_and_b32 v12, 1, v0
  v_lshlrev_b32 v12, 4, v12
  v_mov_b32 v13, 0xffff
  v_lshlrev_b32 v12, v12, v13
  v_bfe_u32 v13, v0, 1, 3
  v_cmp_eq_u32 vcc, 0, v13
  s_nop 1
  v_cndmask_b32 v4, 0, v12, vcc
  v_cmp_eq_u32 vcc, 1, v13
  s_nop 1
  v_cndmask_b32 v5, 0, v12, vcc
  v_cmp_eq_u32 vcc, 2, v13
  s_nop 1
  v_cndmask_b32 v6, 0, v12, vcc
  v_cmp_eq_u32 vcc, 3, v13
  s_nop 1
  v_cndmask_b32 v7, 0, v12, vcc
  v_lshlrev_b32 v24, 16, v20
  v_and_b32 v25, 0xffff0000, v20
  v_lshlrev_b32 v26, 16, v21
  v_and_b32 v27, 0xffff0000, v21
  v_lshlrev_b32 v28, 16, v22
  v_and_b32 v29, 0xffff0000, v22
  v_lshlrev_b32 v30, 16, v23
  v_and_b32 v31, 0xffff0000, v23
  v_readfirstlane_b32 s68, v24
  s_nop 1
  v_subrev_f32 v32, s68, v24
  v_subrev_f32 v33, s68, v25
  s_waitcnt vmcnt(5)
  buffer_load_dwordx4 v[100:103], v8, s[8:11], s54 offen
  s_add_u32 s54, s54, s65
  v_subrev_f32 v34, s68, v26
  v_subrev_f32 v35, s68, v27
  v_subrev_f32 v36, s68, v28
  v_subrev_f32 v37, s68, v29
  v_subrev_f32 v38, s68, v30
  v_subrev_f32 v39, s68, v31
  v_add_f32 v40, v32, v33
  v_mul_f32 v41, v32, v32
  v_fmac_f32 v41, v33, v33
  v_add_f32 v40, v40, v34
  v_fmac_f32 v41, v34, v34
  v_add_f32 v40, v40, v35
  v_fmac_f32 v41, v35, v35
  v_add_f32 v40, v40, v36
  v_fmac_f32 v41, v36, v36
  v_add_f32 v40, v40, v37
  v_fmac_f32 v41, v37, v37
  v_add_f32 v40, v40, v38
  v_fmac_f32 v41, v38, v38
  v_add_f32 v40, v40, v39
  v_fmac_f32 v41, v39, v39
  s_nop 0
  v_add_f32_dpp v40, v40, v40 row_shr:1 row_mask:0xf bank_mask:0xf
  v_add_f32_dpp v41, v41, v41 row_shr:1 row_mask:0xf bank_mask:0xf
  s_nop 0
  v_add_f32_dpp v40, v40, v40 row_shr:2 row_mask:0xf bank_mask:0xf
  s_waitcnt vmcnt(5)
  buffer_load_dwordx4 v[104:107], v8, s[8:11], s54 offen
  s_add_u32 s54, s54, s65
  v_add_f32_dpp v41, v41, v41 row_shr:2 row_mask:0xf bank_mask:0xf
  v_add_f32_dpp v40, v40, v40 row_shr:4 row_mask:0xf bank_mask:0xf
  s_nop 0
  v_add_f32_dpp v41, v41, v41 row_shr:4 row_mask:0xf bank_mask:0xf
  v_add_f32_dpp v40, v40, v40 row_shr:8 row_mask:0xf bank_mask:0xf
  s_nop 0
  v_add_f32_dpp v41, v41, v41 row_shr:8 row_mask:0xf bank_mask:0xf
  v_add_f32_dpp v40, v40, v40 row_bcast:15 row_mask:0xa bank_mask:0xf
  s_nop 0
  v_add_f32_dpp v41, v41, v41 row_bcast:15 row_mask:0xa bank_mask:0xf
  v_add_f32_dpp v40, v40, v40 row_bcast:31 row_mask:0xc bank_mask:0xf
  s_nop 0
  v_add_f32_dpp v41, v41, v41 row_bcast:31 row_mask:0xc bank_mask:0xf
  v_readlane_b32 s69, v40, 63
  v_readlane_b32 s70, v41, 63
  s_nop 0
  v_mov_b32 v10, s69
  v_mov_b32 v11, s70
  v_mul_f32 v10, 0x3b000000, v10
  v_mul_f32 v11, 0x3b000000, v11
  v_fma_f32 v11, -v10, v10, v11
  v_add_f32 v10, s68, v10
  v_max_f32 v11, 0, v11
  v_cvt_pk_bf16_f32 v9, v10, v11
  v_lshlrev_b32 v10, 16, v9
  v_and_b32 v11, 0xffff0000, v9
  v_add_f32 v11, 0x3727c5ac, v11
  v_cvt_pk_bf16_f32 v11, v11, v11
  v_lshlrev_b32 v11, 16, v11
  s_waitcnt vmcnt(5)
  buffer_load_dwordx4 v[108:111], v8, s[8:11], s54 offen
  s_add_u32 s54, s54, s65
  v_sqrt_f32 v11, v11
  s_nop 0
  v_cvt_pk_bf16_f32 v11, v11, v11
  v_lshlrev_b32 v11, 16, v11
  v_rcp_f32 v11, v11
  v_lshlrev_b32 v24, 16, v56
  v_and_b32 v25, 0xffff0000, v56
  v_lshlrev_b32 v26, 16, v57
  v_and_b32 v27, 0xffff0000, v57
  v_lshlrev_b32 v28, 16, v58
  v_and_b32 v29, 0xffff0000, v58
  v_lshlrev_b32 v30, 16, v59
  v_and_b32 v31, 0xffff0000, v59
  v_lshlrev_b32 v32, 16, v60
  v_and_b32 v33, 0xffff0000, v60
  v_lshlrev_b32 v34, 16, v61
  v_and_b32 v35, 0xffff0000, v61
  v_lshlrev_b32 v36, 16, v62
  v_and_b32 v37, 0xffff0000, v62
  v_lshlrev_b32 v38, 16, v63
  v_and_b32 v39, 0xffff0000, v63
  v_lshlrev_b32 v40, 16, v64
  v_and_b32 v41, 0xffff0000, v64
  v_lshlrev_b32 v42, 16, v65
  v_and_b32 v43, 0xffff0000, v65
  s_waitcnt vmcnt(5)
  buffer_load_dwordx4 v[112:115], v8, s[8:11], s54 offen
  s_add_u32 s54, s54, s65
  v_lshlrev_b32 v44, 16, v66
  v_and_b32 v45, 0xffff0000, v66
  v_lshlrev_b32 v46, 16, v67
  v_and_b32 v47, 0xffff0000, v67
  v_lshlrev_b32 v48, 16, v68
  v_and_b32 v49, 0xffff0000, v68
  v_lshlrev_b32 v50, 16, v69
  v_and_b32 v51, 0xffff0000, v69
  v_lshlrev_b32 v52, 16, v70
  v_and_b32 v53, 0xffff0000, v70
  v_lshlrev_b32 v54, 16, v71
  v_and_b32 v55, 0xffff0000, v71
  v_sub_f32 v24, v24, v10
  v_sub_f32 v25, v25, v10
  v_sub_f32 v26, v26, v10
  v_sub_f32 v27, v27, v10
  v_sub_f32 v28, v28, v10
  v_sub_f32 v29, v29, v10
  v_sub_f32 v30, v30, v10
  v_sub_f32 v31, v31, v10
  v_sub_f32 v32, v32, v10
  v_sub_f32 v33, v33, v10
  v_sub_f32 v34, v34, v10
  v_sub_f32 v35, v35, v10
  s_waitcnt vmcnt(5)
  buffer_load_dwordx4 v[116:119], v8, s[8:11], s54 offen
  s_add_u32 s54, s54, s65
  v_sub_f32 v36, v36, v10
  v_sub_f32 v37, v37, v10
  v_sub_f32 v38, v38, v10
  v_sub_f32 v39, v39, v10
  v_sub_f32 v40, v40, v10
  v_sub_f32 v41, v41, v10
  v_sub_f32 v42, v42, v10
  v_sub_f32 v43, v43, v10
  v_sub_f32 v44, v44, v10
  v_sub_f32 v45, v45, v10
  v_sub_f32 v46, v46, v10
  v_sub_f32 v47, v47, v10
  v_sub_f32 v48, v48, v10
  v_sub_f32 v49, v49, v10
  v_sub_f32 v50, v50, v10
  v_sub_f32 v51, v51, v10
  v_sub_f32 v52, v52, v10
  v_sub_f32 v53, v53, v10
  v_sub_f32 v54, v54, v10
  v_sub_f32 v55, v55, v10
  v_cvt_pk_bf16_f32 v25, v24, v25
  v_cvt_pk_bf16_f32 v27, v26, v27
  v_cvt_pk_bf16_f32 v29, v28, v29
  v_cvt_pk_bf16_f32 v31, v30, v31
  s_waitcnt vmcnt(5)
  buffer_load_dwordx4 v[120:123], v8, s[8:11], s54 offen
  s_add_u32 s54, s54, s65
  v_cvt_pk_bf16_f32 v33, v32, v33
  v_cvt_pk_bf16_f32 v35, v34, v35
  v_cvt_pk_bf16_f32 v37, v36, v37
  v_cvt_pk_bf16_f32 v39, v38, v39
  v_cvt_pk_bf16_f32 v41, v40, v41
  v_cvt_pk_bf16_f32 v43, v42, v43
  v_cvt_pk_bf16_f32 v45, v44, v45
  v_cvt_pk_bf16_f32 v47, v46, v47
  v_cvt_pk_bf16_f32 v49, v48, v49
  v_cvt_pk_bf16_f32 v51, v50, v51
  v_cvt_pk_bf16_f32 v53, v52, v53
  v_cvt_pk_bf16_f32 v55, v54, v55
  v_lshlrev_b32 v24, 16, v25
  v_and_b32 v25, 0xffff0000, v25
  v_lshlrev_b32 v26, 16, v27
  v_and_b32 v27, 0xffff0000, v27
  v_lshlrev_b32 v28, 16, v29
  v_and_b32 v29, 0xffff0000, v29
  v_lshlrev_b32 v30, 16, v31
  v_and_b32 v31, 0xffff0000, v31
  v_lshlrev_b32 v32, 16, v33
  v_and_b32 v33, 0xffff0000, v33
  v_lshlrev_b32 v34, 16, v35
  v_and_b32 v35, 0xffff0000, v35
  s_waitcnt vmcnt(5)
  buffer_load_dwordx4 v[124:127], v8, s[8:11], s54 offen
  s_add_u32 s54, s54, s65
  v_lshlrev_b32 v36, 16, v37
  v_and_b32 v37, 0xffff0000, v37
  v_lshlrev_b32 v38, 16, v39
  v_and_b32 v39, 0xffff0000, v39
  v_lshlrev_b32 v40, 16, v41
  v_and_b32 v41, 0xffff0000, v41
  v_lshlrev_b32 v42, 16, v43
  v_and_b32 v43, 0xffff0000, v43
  v_lshlrev_b32 v44, 16, v45
  v_and_b32 v45, 0xffff0000, v45
  v_lshlrev_b32 v46, 16, v47
  v_and_b32 v47, 0xffff0000, v47
  v_lshlrev_b32 v48, 16, v49
  v_and_b32 v49, 0xffff0000, v49
  v_lshlrev_b32 v50, 16, v51
  v_and_b32 v51, 0xffff0000, v51
  v_lshlrev_b32 v52, 16, v53
  v_and_b32 v53, 0xffff0000, v53
  v_lshlrev_b32 v54, 16, v55
  v_and_b32 v55, 0xffff0000, v55
  v_mul_f32 v24, v24, v11
  v_mul_f32 v25, v25, v11
  v_mul_f32 v26, v26, v11
  v_mul_f32 v27, v27, v11
  s_waitcnt vmcnt(5)
  buffer_load_dwordx4 v[128:131], v8, s[8:11], s54 offen
  s_add_u32 s54, s54, s65
  v_mul_f32 v28, v28, v11
  v_mul_f32 v29, v29, v11
  v_mul_f32 v30, v30, v11
  v_mul_f32 v31, v31, v11
  v_mul_f32 v32, v32, v11
  v_mul_f32 v33, v33, v11
  v_mul_f32 v34, v34, v11
  v_mul_f32 v35, v35, v11
  v_mul_f32 v36, v36, v11
  v_mul_f32 v37, v37, v11
  v_mul_f32 v38, v38, v11
  v_mul_f32 v39, v39, v11
  v_mul_f32 v40, v40, v11
  v_mul_f32 v41, v41, v11
  v_mul_f32 v42, v42, v11
  v_mul_f32 v43, v43, v11
  v_mul_f32 v44, v44, v11
  v_mul_f32 v45, v45, v11
  v_mul_f32 v46, v46, v11
  v_mul_f32 v47, v47, v11
  v_mul_f32 v48, v48, v11
  v_mul_f32 v49, v49, v11
  v_mul_f32 v50, v50, v11
  v_mul_f32 v51, v51, v11
  s_waitcnt vmcnt(5)
  buffer_load_dwordx4 v[132:135], v8, s[8:11], s54 offen
  s_add_u32 s54, s54, s65
  v_mul_f32 v52, v52, v11
  v_mul_f32 v53, v53, v11
  v_mul_f32 v54, v54, v11
  v_mul_f32 v55, v55, v11
  v_cvt_pk_bf16_f32 v24, v24, v24
  v_cvt_pk_bf16_f32 v25, v25, v25
  v_cvt_pk_bf16_f32 v26, v26, v26
  v_cvt_pk_bf16_f32 v27, v27, v27
  v_cvt_pk_bf16_f32 v28, v28, v28
  v_cvt_pk_bf16_f32 v29, v29, v29
  v_cvt_pk_bf16_f32 v30, v30, v30
  v_cvt_pk_bf16_f32 v31, v31, v31
  v_cvt_pk_bf16_f32 v32, v32, v32
  v_cvt_pk_bf16_f32 v33, v33, v33
  v_cvt_pk_bf16_f32 v34, v34, v34
  v_cvt_pk_bf16_f32 v35, v35, v35
  v_cvt_pk_bf16_f32 v36, v36, v36
  v_cvt_pk_bf16_f32 v37, v37, v37
  v_cvt_pk_bf16_f32 v38, v38, v38
  v_cvt_pk_bf16_f32 v39, v39, v39
  v_cvt_pk_bf16_f32 v40, v40, v40
  v_cvt_pk_bf16_f32 v41, v41, v41
  v_cvt_pk_bf16_f32 v42, v42, v42
  v_cvt_pk_bf16_f32 v43, v43, v43
  s_waitcnt vmcnt(5)
  buffer_load_dwordx4 v[136:139], v8, s[8:11], s54 offen
  s_add_u32 s54, s54, s65
  v_cvt_pk_bf16_f32 v44, v44, v44
  v_cvt_pk_bf16_f32 v45, v45, v45
  v_cvt_pk_bf16_f32 v46, v46, v46
  v_cvt_pk_bf16_f32 v47, v47, v47
  v_cvt_pk_bf16_f32 v48, v48, v48
  v_cvt_pk_bf16_f32 v49, v49, v49
  v_cvt_pk_bf16_f32 v50, v50, v50
  v_cvt_pk_bf16_f32 v51, v51, v51
  v_cvt_pk_bf16_f32 v52, v52, v52
  v_cvt_pk_bf16_f32 v53, v53, v53
  v_cvt_pk_bf16_f32 v54, v54, v54
  v_cvt_pk_bf16_f32 v55, v55, v55
  v_and_b32 v12, v24, v4
  v_and_b32 v13, v24, v5
  v_and_b32 v14, v24, v6
  v_and_b32 v15, v24, v7
  s_waitcnt vmcnt(5)
  buffer_load_dwordx4 v[140:143], v8, s[8:11], s54 offen
  s_add_u32 s54, s54, s65
  v_mfma_f32_16x16x32_bf16 v[20:23], v[12:15], v[72:75], 0
  v_and_b32 v16, v25, v4
  v_and_b32 v17, v25, v5
  v_and_b32 v18, v25, v6
  v_and_b32 v19, v25, v7
  s_nop 1
  v_mfma_f32_16x16x32_bf16 v[20:23], v[16:19], v[76:79], v[20:23]
  v_and_b32 v12, v26, v4
  v_and_b32 v13, v26, v5
  v_and_b32 v14, v26, v6
  v_and_b32 v15, v26, v7
  s_nop 1
  v_mfma_f32_16x16x32_bf16 v[20:23], v[12:15], v[80:83], v[20:23]
  v_and_b32 v16, v27, v4
  v_and_b32 v17, v27, v5
  v_and_b32 v18, v27, v6
  v_and_b32 v19, v27, v7
  s_nop 1
  v_mfma_f32_16x16x32_bf16 v[20:23], v[16:19], v[84:87], v[20:23]
  v_and_b32 v12, v28, v4
  v_and_b32 v13, v28, v5
  v_and_b32 v14, v28, v6
  v_and_b32 v15, v28, v7
  s_waitcnt vmcnt(5)
  buffer_load_dwordx4 v[144:147], v8, s[8:11], s54 offen
  s_add_u32 s54, s54, s65
  v_mfma_f32_16x16x32_bf16 v[20:23], v[12:15], v[88:91], v[20:23]
  v_and_b32 v16, v29, v4
  v_and_b32 v17, v29, v5
  v_and_b32 v18, v29, v6
  v_and_b32 v19, v29, v7
  s_nop 1
  v_mfma_f32_16x16x32_bf16 v[20:23], v[16:19], v[92:95], v[20:23]
  v_and_b32 v12, v30, v4
  v_and_b32 v13, v30, v5
  v_and_b32 v14, v30, v6
  v_and_b32 v15, v30, v7
  s_nop 1
  v_mfma_f32_16x16x32_bf16 v[20:23], v[12:15], v[96:99], v[20:23]
  v_and_b32 v16, v31, v4
  v_and_b32 v17, v31, v5
  v_and_b32 v18, v31, v6
  v_and_b32 v19, v31, v7
  s_nop 1
  v_mfma_f32_16x16x32_bf16 v[20:23], v[16:19], v[100:103], v[20:23]
  v_and_b32 v12, v32, v4
  v_and_b32 v13, v32, v5
  v_and_b32 v14, v32, v6
  v_and_b32 v15, v32, v7
  s_waitcnt vmcnt(5)
  buffer_load_dwordx4 v[148:151], v8, s[8:11], s54 offen
  s_add_u32 s54, s54, s65
  v_mfma_f32_16x16x32_bf16 v[20:23], v[12:15], v[104:107], v[20:23]
  v_and_b32 v16, v33, v4
  v_and_b32 v17, v33, v5
  v_and_b32 v18, v33, v6
  v_and_b32 v19, v33, v7
  s_nop 1
  v_mfma_f32_16x16x32_bf16 v[20:23], v[16:19], v[108:111], v[20:23]
  v_and_b32 v12, v34, v4
  v_and_b32 v13, v34, v5
  v_and_b32 v14, v34, v6
  v_and_b32 v15, v34, v7
  s_nop 1
  v_mfma_f32_16x16x32_bf16 v[20:23], v[12:15], v[112:115], v[20:23]
  v_and_b32 v16, v35, v4
  v_and_b32 v17, v35, v5
  v_and_b32 v18, v35, v6
  v_and_b32 v19, v35, v7
  s_nop 1
  v_mfma_f32_16x16x32_bf16 v[20:23], v[16:19], v[116:119], v[20:23]
  v_and_b32 v12, v36, v4
  v_and_b32 v13, v36, v5
  v_and_b32 v14, v36, v6
  v_and_b32 v15, v36, v7
  s_waitcnt vmcnt(5)
  buffer_load_dwordx4 v[152:155], v8, s[8:11], s54 offen
  s_add_u32 s54, s54, s65
  v_mfma_f32_16x16x32_bf16 v[20:23], v[12:15], v[120:123], v[20:23]
  v_and_b32 v16, v37, v4
  v_and_b32 v17, v37, v5
  v_and_b32 v18, v37, v6
  v_and_b32 v19, v37, v7
  s_nop 1
  v_mfma_f32_16x16x32_bf16 v[20:23], v[16:19], v[124:127], v[20:23]
  v_and_b32 v12, v38, v4
  v_and_b32 v13, v38, v5
  v_and_b32 v14, v38, v6
  v_and_b32 v15, v38, v7
  s_nop 1
  v_mfma_f32_16x16x32_bf16 v[20:23], v[12:15], v[128:131], v[20:23]
  v_and_b32 v16, v39, v4
  v_and_b32 v17, v39, v5
  v_and_b32 v18, v39, v6
  v_and_b32 v19, v39, v7
  s_waitcnt vmcnt(5)
  buffer_load_dwordx4 v[156:159], v8, s[8:11], s54 offen
  s_add_u32 s54, s54, s65
  v_mfma_f32_16x16x32_bf16 v[20:23], v[16:19], v[132:135], v[20:23]
  v_and_b32 v12, v40, v4
  v_and_b32 v13, v40, v5
  v_and_b32 v14, v40, v6
  v_and_b32 v15, v40, v7
  s_waitcnt vmcnt(5)
  buffer_load_dwordx4 v[160:163], v8, s[8:11], s54 offen
  s_add_u32 s54, s54, s65
  v_mfma_f32_16x16x32_bf16 v[20:23], v[12:15], v[136:139], v[20:23]
  v_and_b32 v16, v41, v4
  v_and_b32 v17, v41, v5
  v_and_b32 v18, v41, v6
  v_and_b32 v19, v41, v7
  s_waitcnt vmcnt(5)
  buffer_load_dwordx4 v[164:167], v8, s[8:11], s54 offen
  s_add_u32 s54, s54, s65
  v_mfma_f32_16x16x32_bf16 v[20:23], v[16:19], v[140:143], v[20:23]
  v_and_b32 v12, v42, v4
  v_and_b32 v13, v42, v5
  v_and_b32 v14, v42, v6
  v_and_b32 v15, v42, v7
  s_waitcnt vmcnt(5)
  buffer_load_dwordx4 v[72:75], v8, s[8:11], s54 offen
  s_add_u32 s54, s54, s65
  v_mfma_f32_16x16x32_bf16 v[20:23], v[12:15], v[144:147], v[20:23]
  v_and_b32 v16, v43, v4
  v_and_b32 v17, v43, v5
  v_and_b32 v18, v43, v6
  v_and_b32 v19, v43, v7
  s_waitcnt vmcnt(5)
  buffer_load_dwordx4 v[76:79], v8, s[8:11], s54 offen
  s_add_u32 s54, s54, s65
  v_mfma_f32_16x16x32_bf16 v[20:23], v[16:19], v[148:151], v[20:23]
  v_and_b32 v12, v44, v4
  v_and_b32 v13, v44, v5
  v_and_b32 v14, v44, v6
  v_and_b32 v15, v44, v7
  s_waitcnt vmcnt(5)
  buffer_load_dwordx4 v[80:83], v8, s[8:11], s54 offen
  s_add_u32 s54, s54, s65
  v_mfma_f32_16x16x32_bf16 v[20:23], v[12:15], v[152:155], v[20:23]
  v_and_b32 v16, v45, v4
  v_and_b32 v17, v45, v5
  v_and_b32 v18, v45, v6
  v_and_b32 v19, v45, v7
  s_waitcnt vmcnt(5)
  buffer_load_dwordx4 v[84:87], v8, s[8:11], s54 offen
  s_add_u32 s54, s54, s65
  v_mfma_f32_16x16x32_bf16 v[20:23], v[16:19], v[156:159], v[20:23]
  v_and_b32 v12, v46, v4
  v_and_b32 v13, v46, v5
  v_and_b32 v14, v46, v6
  v_and_b32 v15, v46, v7
  s_waitcnt vmcnt(5)
  buffer_load_dwordx4 v[88:91], v8, s[8:11], s54 offen
  s_add_u32 s54, s54, s65
  v_mfma_f32_16x16x32_bf16 v[20:23], v[12:15], v[160:163], v[20:23]
  v_and_b32 v16, v47, v4
  v_and_b32 v17, v47, v5
  v_and_b32 v18, v47, v6
  v_and_b32 v19, v47, v7
  s_waitcnt vmcnt(5)
  buffer_load_dwordx4 v[92:95], v8, s[8:11], s54 offen
  s_add_u32 s54, s54, s65
  v_mfma_f32_16x16x32_bf16 v[20:23], v[16:19], v[164:167], v[20:23]
  v_and_b32 v12, v48, v4
  v_and_b32 v13, v48, v5
  v_and_b32 v14, v48, v6
  v_and_b32 v15, v48, v7
  s_waitcnt vmcnt(5)
  buffer_load_dwordx4 v[96:99], v8, s[8:11], s54 offen
  s_add_u32 s54, s54, s65
  v_mfma_f32_16x16x32_bf16 v[20:23], v[12:15], v[72:75], v[20:23]
  v_and_b32 v16, v49, v4
  v_and_b32 v17, v49, v5
  v_and_b32 v18, v49, v6
  v_and_b32 v19, v49, v7
  s_waitcnt vmcnt(5)
  buffer_load_dwordx4 v[100:103], v8, s[8:11], s54 offen
  v_mfma_f32_16x16x32_bf16 v[20:23], v[16:19], v[76:79], v[20:23]
  v_and_b32 v12, v50, v4
  v_and_b32 v13, v50, v5
  v_and_b32 v14, v50, v6
  v_and_b32 v15, v50, v7
  s_waitcnt vmcnt(5)
  s_nop 0
  v_mfma_f32_16x16x32_bf16 v[20:23], v[12:15], v[80:83], v[20:23]
  v_and_b32 v16, v51, v4
  v_and_b32 v17, v51, v5
  v_and_b32 v18, v51, v6
  v_and_b32 v19, v51, v7
  s_waitcnt vmcnt(4)
  s_nop 0
  v_mfma_f32_16x16x32_bf16 v[20:23], v[16:19], v[84:87], v[20:23]
  v_and_b32 v12, v52, v4
  v_and_b32 v13, v52, v5
  v_and_b32 v14, v52, v6
  v_and_b32 v15, v52, v7
  s_waitcnt vmcnt(3)
  s_nop 0
  v_mfma_f32_16x16x32_bf16 v[20:23], v[12:15], v[88:91], v[20:23]
  v_and_b32 v16, v53, v4
  v_and_b32 v17, v53, v5
  v_and_b32 v18, v53, v6
  v_and_b32 v19, v53, v7
  s_waitcnt vmcnt(2)
  s_nop 0
  v_mfma_f32_16x16x32_bf16 v[20:23], v[16:19], v[92:95], v[20:23]
  v_and_b32 v12, v54, v4
  v_and_b32 v13, v54, v5
  v_and_b32 v14, v54, v6
  v_and_b32 v15, v54, v7
  s_waitcnt vmcnt(1)
  s_nop 0
  v_mfma_f32_16x16x32_bf16 v[20:23], v[12:15], v[96:99], v[20:23]
  v_and_b32 v16, v55, v4
  v_and_b32 v17, v55, v5
  v_and_b32 v18, v55, v6
  v_and_b32 v19, v55, v7
  s_waitcnt vmcnt(0)
  s_nop 0
  v_mfma_f32_16x16x32_bf16 v[20:23], v[16:19], v[100:103], v[20:23]
  s_lshl_b32 s52, s59, 9
  s_add_u32 s52, s52, 104448
  v_lshlrev_b32 v8, 5, v3
  v_lshl_add_u32 v8, v2, 4, v8
  v_add_u32 v8, s52, v8
  s_mov_b32 exec_hi, 0
  s_nop 1
  ds_write_b128 v8, v[20:23]
  s_mov_b64 exec, -1
  s_cmp_lg_u32 s59, 0
  s_cbranch_scc1 L_aux4
  v_lshlrev_b32 v8, 3, v0
  v_add_u32 v11, 100352, v8
  v_lshlrev_b32 v9, 2, v0
  v_add_u32 v10, 106496, v9
  s_mov_b32 s75, 1000000
L_pQ:
  ds_read_b64 v[12:13], v11 offset:4096
  ds_read_b64 v[14:15], v11 offset:4608
  ds_read_b64 v[16:17], v11 offset:5120
  ds_read_b64 v[18:19], v11 offset:5632
  s_sub_u32 s75, s75, 1
  s_cbranch_scc1 L_pQ_ok
  s_waitcnt lgkmcnt(0)
  v_max3_u32 v20, v12, v13, v14
  v_max3_u32 v20, v20, v15, v16
  v_max3_u32 v20, v20, v17, v18
  v_max_u32 v20, v20, v19
  v_cmp_eq_u32 vcc, -1, v20
  s_cbranch_vccnz L_pQ
L_pQ_ok:
  v_add_f32 v12, v12, v14
  v_add_f32 v13, v13, v15
  v_add_f32 v12, v12, v16
  v_add_f32 v13, v13, v17
  v_add_f32 v12, v12, v18
  v_add_f32 v13, v13, v19
  v_cvt_pk_bf16_f32 v12, v12, v13
  ds_write_b32 v10, v12
L_qdone:
  v_and_b32 v9, 7, v0
  v_lshlrev_b32 v9, 3, v9
  v_add_u32 v9, 106752, v9
  s_mov_b32 s75, 1000000
L_pM:
  s_sleep 4
  ds_read_b64 v[12:13], v9
  s_sub_u32 s75, s75, 1
  s_cbranch_scc1 L_pM_ok
  s_waitcnt lgkmcnt(0)
  v_max_u32 v14, v12, v13
  v_cmp_eq_u32 vcc, -1, v14
  s_cbranch_vccnz L_pM
L_pM_ok:
  v_mov_b32 v16, v12
  s_nop 1
  v_max_f32_dpp v16, v16, v16 quad_perm:[1,0,3,2] row_mask:0xf bank_mask:0xf
  s_nop 1
  v_max_f32_dpp v16, v16, v16 quad_perm:[2,3,0,1] row_mask:0xf bank_mask:0xf
  s_nop 1
  v_max_f32_dpp v16, v16, v16 row_half_mirror row_mask:0xf bank_mask:0xf
  v_sub_f32 v14, v12, v16
  v_mul_f32 v14, 0x3fb8aa3b, v14
  v_exp_f32 v14, v14
  s_nop 0
  v_mul_f32 v17, v13, v14
  s_nop 1
  v_add_f32_dpp v17, v17, v17 quad_perm:[1,0,3,2] row_mask:0xf bank_mask:0xf
  s_nop 1
  v_add_f32_dpp v17, v17, v17 quad_perm:[2,3,0,1] row_mask:0xf bank_mask:0xf
  s_nop 1
  v_add_f32_dpp v17, v17, v17 row_half_mirror row_mask:0xf bank_mask:0xf
  s_getreg_b32 s53, hwreg(HW_REG_XCC_ID, 0, 4)
  s_xor_b32 s53, s53, s29
  v_mov_b32 v18, s29
  v_mov_b32 v19, s53
  s_lshl_b32 s52, s55, 1
  s_add_u32 s52, s52, s56
  s_lshl_b32 s52, s52, 2
  s_add_u32 s52, s52, s57
  s_lshl_b32 s53, s52, 7
  s_add_u32 s53, s53, 4096
  s_lshl_b32 s52, s52, 9
  s_add_u32 s52, s52, 36864
  s_mov_b64 exec, 1
  buffer_store_dwordx4 v[16:19], v8, s[24:27], s53 offen sc1
  s_mov_b64 exec, -1
  s_add_u32 s53, s52, 131072
  v_readlane_b32 s44, v14, 0
  v_readlane_b32 s45, v14, 1
  v_readlane_b32 s46, v14, 2
  v_readlane_b32 s47, v14, 3
  v_readlane_b32 s48, v14, 4
  v_readlane_b32 s49, v14, 5
  v_readlane_b32 s50, v14, 6
  v_readlane_b32 s51, v14, 7
  v_and_b32 v9, 1, v0
  v_lshlrev_b32 v9, 4, v9
  v_lshrrev_b32 v9, v9, s29
  v_bfe_u32 v10, v9, 8, 8
  v_and_b32 v9, 0xff, v9
  s_setprio 2
  s_mov_b32 s75, 1000000
L_pO:
  ds_read_b64 v[12:13], v11 offset:0
  ds_read_b64 v[14:15], v11 offset:512
  ds_read_b64 v[16:17], v11 offset:1024
  ds_read_b64 v[18:19], v11 offset:1536
  ds_read_b64 v[20:21], v11 offset:2048
  ds_read_b64 v[22:23], v11 offset:2560
  ds_read_b64 v[24:25], v11 offset:3072
  ds_read_b64 v[26:27], v11 offset:3584
  s_sub_u32 s75, s75, 1
  s_cbranch_scc1 L_pO_ok
  s_waitcnt lgkmcnt(0)
  v_max3_u32 v28, v12, v14, v16
  v_max3_u32 v29, v18, v20, v22
  v_max3_u32 v28, v28, v24, v26
  v_max_u32 v28, v28, v29
  v_cmp_eq_u32 vcc, -1, v28
  s_cbranch_vccnz L_pO
L_pO_ok:
L_w_ct_0:
  s_cbranch_execz L_w_ct_1
  v_mul_f32 v12, s44, v12
  v_mul_f32 v13, s44, v13
  v_mul_f32 v20, s48, v20
  v_mul_f32 v21, s48, v21
  v_fmac_f32 v12, s45, v14
  v_fmac_f32 v13, s45, v15
  v_fmac_f32 v20, s49, v22
  v_fmac_f32 v21, s49, v23
  v_fmac_f32 v12, s46, v16
L_w_ct_1:
  s_cbranch_execz L_w_ct_2
  v_fmac_f32 v13, s46, v17
  v_fmac_f32 v20, s50, v24
  v_fmac_f32 v21, s50, v25
  v_fmac_f32 v12, s47, v18
  v_fmac_f32 v13, s47, v19
  v_fmac_f32 v20, s51, v26
  v_fmac_f32 v21, s51, v27
  v_add_f32 v12, v12, v20
  v_add_f32 v13, v13, v21
  v_and_or_b32 v12, v12, s31, v9
  v_and_or_b32 v13, v13, s31, v10
  buffer_store_dwordx2 v[12:13], v8, s[24:27], s52 offen
L_w_ct_2:
  s_cbranch_execz L_wret1
  buffer_store_dwordx2 v[12:13], v8, s[24:27], s53 offen sc1
L_aux4:
  s_cmp_lt_u32 s2, 43
  s_cbranch_scc1 L_aux5
  s_cmp_lg_u32 s57, 1
  s_cbranch_scc1 L_fin
L_aux5:
  s_setprio 3
  v_lshrrev_b32 v33, 2, v3
  v_lshl_add_u32 v33, v2, 3, v33
  v_and_b32 v34, 3, v0
  v_bfe_u32 v6, v3, 2, 1
  v_mul_u32_u24 v6, 1088, v6
  v_lshl_add_u32 v6, v2, 4, v6
  v_add_u32 v6, 107776, v6
  v_mov_b32 v35, 106816
  s_cmp_lt_u32 s2, 43
  s_cbranch_scc1 L_aux_m
  v_lshlrev_b32 v10, 7, v33
  v_lshl_add_u32 v10, v34, 3, v10
  s_lshl_b32 s52, s59, 5
  v_add_u32 v10, s52, v10
  v_lshlrev_b32 v7, 3, v34
  v_lshrrev_b32 v7, v7, s29
  v_and_b32 v7, 0xff, v7
  v_lshlrev_b32 v5, 2, v0
  s_and_b32 s70, s2, 63
  s_lshl_b32 s70, s70, 2
  s_add_u32 s70, s70, s59
  s_lshl_b32 s70, s70, 7
  s_add_u32 s70, s70, 299008
  s_mov_b32 s75, 1000000
L_fr0:
  s_sleep 2
  ds_read_b32 v12, v35 offset:0
  s_sub_u32 s75, s75, 1
  s_cbranch_scc1 L_fr0_ok
  s_waitcnt lgkmcnt(0)
  v_cmp_eq_u32 vcc, -1, v12
  s_cbranch_vccnz L_fr0
L_fr0_ok:
  ds_read_b64_tr_b16 v[64:65], v10 offset:0
  ds_read_b64_tr_b16 v[66:67], v10 offset:512
  ds_read_b64_tr_b16 v[68:69], v10 offset:4096
  ds_read_b64_tr_b16 v[70:71], v10 offset:4608
  s_mov_b32 s75, 1000000
L_fr1:
  ds_read_b32 v12, v35 offset:4
  s_sub_u32 s75, s75, 1
  s_cbranch_scc1 L_fr1_ok
  s_waitcnt lgkmcnt(0)
  v_cmp_eq_u32 vcc, -1, v12
  s_cbranch_vccnz L_fr1
L_fr1_ok:
  ds_read_b64_tr_b16 v[72:73], v10 offset:8192
  ds_read_b64_tr_b16 v[74:75], v10 offset:8704
  ds_read_b64_tr_b16 v[76:77], v10 offset:12288
  ds_read_b64_tr_b16 v[78:79], v10 offset:12800
  s_mov_b32 s75, 1000000
L_fr2:
  ds_read_b32 v12, v35 offset:8
  s_sub_u32 s75, s75, 1
  s_cbranch_scc1 L_fr2_ok
  s_waitcnt lgkmcnt(0)
  v_cmp_eq_u32 vcc, -1, v12
  s_cbranch_vccnz L_fr2
L_fr2_ok:
  ds_read_b64_tr_b16 v[80:81], v10 offset:16384
  ds_read_b64_tr_b16 v[82:83], v10 offset:16896
  ds_read_b64_tr_b16 v[84:85], v10 offset:20480
  ds_read_b64_tr_b16 v[86:87], v10 offset:20992
  s_mov_b32 s75, 1000000
L_fr3:
  ds_read_b32 v12, v35 offset:12
  s_sub_u32 s75, s75, 1
  s_cbranch_scc1 L_fr3_ok
  s_waitcnt lgkmcnt(0)
  v_cmp_eq_u32 vcc, -1, v12
  s_cbranch_vccnz L_fr3
L_fr3_ok:
  ds_read_b64_tr_b16 v[88:89], v10 offset:24576
  ds_read_b64_tr_b16 v[90:91], v10 offset:25088
  ds_read_b64_tr_b16 v[92:93], v10 offset:28672
  ds_read_b64_tr_b16 v[94:95], v10 offset:29184
  s_mov_b32 s75, 1000000
L_fr4:
  ds_read_b32 v12, v35 offset:16
  s_sub_u32 s75, s75, 1
  s_cbranch_scc1 L_fr4_ok
  s_waitcnt lgkmcnt(0)
  v_cmp_eq_u32 vcc, -1, v12
  s_cbranch_vccnz L_fr4
L_fr4_ok:
  ds_read_b64_tr_b16 v[96:97], v10 offset:32768
  ds_read_b64_tr_b16 v[98:99], v10 offset:33280
  ds_read_b64_tr_b16 v[100:101], v10 offset:36864
  ds_read_b64_tr_b16 v[102:103], v10 offset:37376
  s_mov_b32 s75, 1000000
L_fr5:
  ds_read_b32 v12, v35 offset:20
  s_sub_u32 s75, s75, 1
  s_cbranch_scc1 L_fr5_ok
  s_waitcnt lgkmcnt(0)
  v_cmp_eq_u32 vcc, -1, v12
  s_cbranch_vccnz L_fr5
L_fr5_ok:
  ds_read_b64_tr_b16 v[104:105], v10 offset:40960
  ds_read_b64_tr_b16 v[106:107], v10 offset:41472
  ds_read_b64_tr_b16 v[108:109], v10 offset:45056
  ds_read_b64_tr_b16 v[110:111], v10 offset:45568
  s_mov_b32 s75, 1000000
L_fr6:
  ds_read_b32 v12, v35 offset:24
  s_sub_u32 s75, s75, 1
  s_cbranch_scc1 L_fr6_ok
  s_waitcnt lgkmcnt(0)
  v_cmp_eq_u32 vcc, -1, v12
  s_cbranch_vccnz L_fr6
L_fr6_ok:
  ds_read_b64_tr_b16 v[112:113], v10 offset:49152
  ds_read_b64_tr_b16 v[114:115], v10 offset:49664
  ds_read_b64_tr_b16 v[116:117], v10 offset:53248
  ds_read_b64_tr_b16 v[118:119], v10 offset:53760
  s_mov_b32 s75, 1000000
L_fr7:
  ds_read_b32 v12, v35 offset:28
  s_sub_u32 s75, s75, 1
  s_cbranch_scc1 L_fr7_ok
  s_waitcnt lgkmcnt(0)
  v_cmp_eq_u32 vcc, -1, v12
  s_cbranch_vccnz L_fr7
L_fr7_ok:
  ds_read_b64_tr_b16 v[120:121], v10 offset:57344
  ds_read_b64_tr_b16 v[122:123], v10 offset:57856
  ds_read_b64_tr_b16 v[124:125], v10 offset:61440
  ds_read_b64_tr_b16 v[126:127], v10 offset:61952
  s_waitcnt lgkmcnt(0)
L_w_ra_0:
  s_cbranch_execz L_w_ra_1
  s_barrier
  ds_read_b128 v[16:19], v6 offset:0
  ds_read_b128 v[20:23], v6 offset:64
  ds_read_b128 v[24:27], v6 offset:128
  ds_read_b128 v[28:31], v6 offset:192
  ds_read_b128 v[32:35], v6 offset:256
  ds_read_b128 v[36:39], v6 offset:320
L_w_ra_1:
  s_cbranch_execz L_w_ra_2
  ds_read_b128 v[40:43], v6 offset:384
  ds_read_b128 v[44:47], v6 offset:448
  ds_read_b128 v[48:51], v6 offset:512
  ds_read_b128 v[52:55], v6 offset:576
  ds_read_b128 v[56:59], v6 offset:640
  ds_read_b128 v[60:63], v6 offset:704
  s_waitcnt lgkmcnt(11)
  v_mfma_f32_16x16x32_bf16 v[12:15], v[16:19], v[64:67], 0
L_w_ra_2:
  s_cbranch_execz L_w_ra_3
  ds_read_b128 v[16:19], v6 offset:768
  s_waitcnt lgkmcnt(8)
  v_mfma_f32_16x16x32_bf16 v[12:15], v[20:23], v[68:71], v[12:15]
  ds_read_b128 v[20:23], v6 offset:832
  v_mfma_f32_16x16x32_bf16 v[12:15], v[24:27], v[72:75], v[12:15]
  ds_read_b128 v[24:27], v6 offset:896
  v_mfma_f32_16x16x32_bf16 v[12:15], v[28:31], v[76:79], v[12:15]
  ds_read_b128 v[28:31], v6 offset:960
L_w_ra_3:
  s_cbranch_execz L_w_ra_4
  v_mfma_f32_16x16x32_bf16 v[12:15], v[32:35], v[80:83], v[12:15]
  s_waitcnt lgkmcnt(7)
  v_mfma_f32_16x16x32_bf16 v[12:15], v[36:39], v[84:87], v[12:15]
  v_mfma_f32_16x16x32_bf16 v[12:15], v[40:43], v[88:91], v[12:15]
  v_mfma_f32_16x16x32_bf16 v[12:15], v[44:47], v[92:95], v[12:15]
  v_mfma_f32_16x16x32_bf16 v[12:15], v[48:51], v[96:99], v[12:15]
  s_waitcnt lgkmcnt(3)
  v_mfma_f32_16x16x32_bf16 v[12:15], v[52:55], v[100:103], v[12:15]
L_w_ra_4:
  s_cbranch_execz L_wret
  v_mfma_f32_16x16x32_bf16 v[12:15], v[56:59], v[104:107], v[12:15]
  v_mfma_f32_16x16x32_bf16 v[12:15], v[60:63], v[108:111], v[12:15]
  v_mfma_f32_16x16x32_bf16 v[12:15], v[16:19], v[112:115], v[12:15]
  s_waitcnt lgkmcnt(0)
  v_mfma_f32_16x16x32_bf16 v[12:15], v[20:23], v[116:119], v[12:15]
  v_mfma_f32_16x16x32_bf16 v[12:15], v[24:27], v[120:123], v[12:15]
  v_mfma_f32_16x16x32_bf16 v[12:15], v[28:31], v[124:127], v[12:15]
  s_mov_b32 exec_hi, 0
  s_nop 6
  v_and_or_b32 v12, v12, s31, v7
  buffer_store_dword v12, v5, s[24:27], s70 offen sc1
  s_mov_b64 exec, -1
  s_branch L_fin
L_aux_m:
  v_lshlrev_b32 v10, 6, v33
  v_and_b32 v11, 1, v0
  v_lshl_add_u32 v10, v11, 3, v10
  v_bfe_u32 v11, v0, 1, 1
  v_mul_u32_u24 v11, 32800, v11
  v_add_u32 v10, v11, v10
  s_lshl_b32 s52, s59, 4
  v_add_u32 v10, s52, v10
  v_mul_u32_u24 v36, 1056, v33
  v_lshl_add_u32 v36, v34, 3, v36
  s_lshl_b32 s52, s59, 8
  s_add_u32 s52, s52, 65600
  v_add_u32 v36, s52, v36
  v_and_b32 v4, 1, v2
  v_lshlrev_b32 v9, 10, v4
  buffer_load_ushort v165, v9, s[4:7], 0 offen
  v_lshlrev_b32 v166, 8, v4
  v_lshl_add_u32 v166, v3, 4, v166
  v_add_u32 v166, 110080, v166
  v_lshlrev_b32 v4, 6, v4
  v_lshl_add_u32 v4, v3, 1, v4
  s_lshl_b32 s52, s59, 4
  s_add_u32 s52, s52, 106880
  v_add_u32 v4, s52, v4
  v_and_b32 v8, 1, v3
  v_lshlrev_b32 v8, 6, v8
  v_lshl_add_u32 v8, v2, 4, v8
  v_add_u32 v8, 106880, v8
  v_mov_b32 v11, 107520
  v_lshrrev_b32 v9, 2, v3
  v_cmp_eq_u32 vcc, 0, v9
  s_nop 1
  v_cndmask_b32 v160, v11, v8, vcc
  v_cmp_eq_u32 vcc, 1, v9
  s_nop 1
  v_cndmask_b32 v161, v11, v8, vcc
  v_cmp_eq_u32 vcc, 2, v9
  s_nop 1
  v_cndmask_b32 v162, v11, v8, vcc
  v_cmp_eq_u32 vcc, 3, v9
  s_nop 1
  v_cndmask_b32 v163, v11, v8, vcc
  v_mul_u32_u24 v5, 5504, v2
  v_lshl_add_u32 v5, v3, 3, v5
  s_mul_i32 s52, s59, 44032
  s_lshl_b32 s53, s2, 7
  s_add_u32 s52, s52, s53
  s_add_u32 s52, s52, 856064
  s_add_u32 s53, s52, 22016
  v_and_b32 v7, 1, v0
  v_lshlrev_b32 v7, 4, v7
  v_lshrrev_b32 v7, v7, s29
  v_bfe_u32 v164, v7, 8, 8
  v_and_b32 v7, 0xff, v7
  v_mov_b32 v40, 0x3f803f80
  v_mov_b32 v41, 0x3f803f80
  v_mov_b32 v42, 0x3f803f80
  v_mov_b32 v43, 0x3f803f80
  s_mov_b32 s75, 1000000
L_fm0:
  s_sleep 2
  ds_read_b32 v12, v35 offset:0
  s_sub_u32 s75, s75, 1
  s_cbranch_scc1 L_fm0_ok
  s_waitcnt lgkmcnt(0)
  v_cmp_eq_u32 vcc, -1, v12
  s_cbranch_vccnz L_fm0
L_fm0_ok:
  ds_read_b64_tr_b16 v[64:65], v10 offset:0
  ds_read_b64_tr_b16 v[66:67], v10 offset:256
  ds_read_b64_tr_b16 v[68:69], v10 offset:2048
  ds_read_b64_tr_b16 v[70:71], v10 offset:2304
  s_mov_b32 s75, 1000000
L_fm1:
  ds_read_b32 v12, v35 offset:4
  s_sub_u32 s75, s75, 1
  s_cbranch_scc1 L_fm1_ok
  s_waitcnt lgkmcnt(0)
  v_cmp_eq_u32 vcc, -1, v12
  s_cbranch_vccnz L_fm1
L_fm1_ok:
  v_mfma_f32_16x16x32_bf16 v[44:47], v[40:43], v[64:67], 0
  v_mfma_f32_16x16x32_bf16 v[44:47], v[40:43], v[68:71], v[44:47]
  ds_read_b64_tr_b16 v[72:73], v10 offset:4096
  ds_read_b64_tr_b16 v[74:75], v10 offset:4352
  ds_read_b64_tr_b16 v[76:77], v10 offset:6144
  ds_read_b64_tr_b16 v[78:79], v10 offset:6400
  s_mov_b32 s75, 1000000
L_fm2:
  ds_read_b32 v12, v35 offset:8
  s_sub_u32 s75, s75, 1
  s_cbranch_scc1 L_fm2_ok
  s_waitcnt lgkmcnt(0)
  v_cmp_eq_u32 vcc, -1, v12
  s_cbranch_vccnz L_fm2
L_fm2_ok:
  v_mfma_f32_16x16x32_bf16 v[44:47], v[40:43], v[72:75], v[44:47]
  v_mfma_f32_16x16x32_bf16 v[44:47], v[40:43], v[76:79], v[44:47]
  ds_read_b64_tr_b16 v[80:81], v10 offset:8192
  ds_read_b64_tr_b16 v[82:83], v10 offset:8448
  ds_read_b64_tr_b16 v[84:85], v10 offset:10240
  ds_read_b64_tr_b16 v[86:87], v10 offset:10496
  s_mov_b32 s75, 1000000
L_fm3:
  ds_read_b32 v12, v35 offset:12
  s_sub_u32 s75, s75, 1
  s_cbranch_scc1 L_fm3_ok
  s_waitcnt lgkmcnt(0)
  v_cmp_eq_u32 vcc, -1, v12
  s_cbranch_vccnz L_fm3
L_fm3_ok:
  v_mfma_f32_16x16x32_bf16 v[44:47], v[40:43], v[80:83], v[44:47]
  v_mfma_f32_16x16x32_bf16 v[44:47], v[40:43], v[84:87], v[44:47]
  ds_read_b64_tr_b16 v[88:89], v10 offset:12288
  ds_read_b64_tr_b16 v[90:91], v10 offset:12544
  ds_read_b64_tr_b16 v[92:93], v10 offset:14336
  ds_read_b64_tr_b16 v[94:95], v10 offset:14592
  s_mov_b32 s75, 1000000
L_fm4:
  ds_read_b32 v12, v35 offset:16
  s_sub_u32 s75, s75, 1
  s_cbranch_scc1 L_fm4_ok
  s_waitcnt lgkmcnt(0)
  v_cmp_eq_u32 vcc, -1, v12
  s_cbranch_vccnz L_fm4
L_fm4_ok:
  v_mfma_f32_16x16x32_bf16 v[44:47], v[40:43], v[88:91], v[44:47]
  v_mfma_f32_16x16x32_bf16 v[44:47], v[40:43], v[92:95], v[44:47]
  ds_read_b64_tr_b16 v[96:97], v10 offset:16384
  ds_read_b64_tr_b16 v[98:99], v10 offset:16640
  ds_read_b64_tr_b16 v[100:101], v10 offset:18432
  ds_read_b64_tr_b16 v[102:103], v10 offset:18688
  s_mov_b32 s75, 1000000
L_fm5:
  ds_read_b32 v12, v35 offset:20
  s_sub_u32 s75, s75, 1
  s_cbranch_scc1 L_fm5_ok
  s_waitcnt lgkmcnt(0)
  v_cmp_eq_u32 vcc, -1, v12
  s_cbranch_vccnz L_fm5
L_fm5_ok:
  v_mfma_f32_16x16x32_bf16 v[44:47], v[40:43], v[96:99], v[44:47]
  v_mfma_f32_16x16x32_bf16 v[44:47], v[40:43], v[100:103], v[44:47]
  ds_read_b64_tr_b16 v[104:105], v10 offset:20480
  ds_read_b64_tr_b16 v[106:107], v10 offset:20736
  ds_read_b64_tr_b16 v[108:109], v10 offset:22528
  ds_read_b64_tr_b16 v[110:111], v10 offset:22784
  s_mov_b32 s75, 1000000
L_fm6:
  ds_read_b32 v12, v35 offset:24
  s_sub_u32 s75, s75, 1
  s_cbranch_scc1 L_fm6_ok
  s_waitcnt lgkmcnt(0)
  v_cmp_eq_u32 vcc, -1, v12
  s_cbranch_vccnz L_fm6
L_fm6_ok:
  v_mfma_f32_16x16x32_bf16 v[44:47], v[40:43], v[104:107], v[44:47]
  v_mfma_f32_16x16x32_bf16 v[44:47], v[40:43], v[108:111], v[44:47]
  ds_read_b64_tr_b16 v[112:113], v10 offset:24576
  ds_read_b64_tr_b16 v[114:115], v10 offset:24832
  ds_read_b64_tr_b16 v[116:117], v10 offset:26624
  ds_read_b64_tr_b16 v[118:119], v10 offset:26880
  s_mov_b32 s75, 1000000
L_fm7:
  ds_read_b32 v12, v35 offset:28
  s_sub_u32 s75, s75, 1
  s_cbranch_scc1 L_fm7_ok
  s_waitcnt lgkmcnt(0)
  v_cmp_eq_u32 vcc, -1, v12
  s_cbranch_vccnz L_fm7
L_fm7_ok:
  v_mfma_f32_16x16x32_bf16 v[44:47], v[40:43], v[112:115], v[44:47]
  v_mfma_f32_16x16x32_bf16 v[44:47], v[40:43], v[116:119], v[44:47]
  ds_read_b64_tr_b16 v[120:121], v10 offset:28672
  ds_read_b64_tr_b16 v[122:123], v10 offset:28928
  ds_read_b64_tr_b16 v[124:125], v10 offset:30720
  ds_read_b64_tr_b16 v[126:127], v10 offset:30976
  s_waitcnt lgkmcnt(0) vmcnt(0)
  v_mfma_f32_16x16x32_bf16 v[44:47], v[40:43], v[120:123], v[44:47]
  v_mfma_f32_16x16x32_bf16 v[44:47], v[40:43], v[124:127], v[44:47]
  v_lshlrev_b32 v165, 16, v165
  s_nop 6
  v_mov_b32 v167, v44
  v_and_b32 v11, 7, v0
  v_lshlrev_b32 v11, 2, v11
  v_add_u32 v11, 106848, v11
  s_mov_b32 s75, 1000000
L_fd:
  ds_read_b32 v12, v11 offset:0
  s_sub_u32 s75, s75, 1
  s_cbranch_scc1 L_fd_ok
  s_waitcnt lgkmcnt(0)
  v_cmp_eq_u32 vcc, -1, v12
  s_cbranch_vccnz L_fd
L_fd_ok:
  ds_read_b64_tr_b16 v[128:129], v36 offset:0
  ds_read_b64_tr_b16 v[130:131], v36 offset:4224
  ds_read_b64_tr_b16 v[132:133], v36 offset:32
  ds_read_b64_tr_b16 v[134:135], v36 offset:4256
  ds_read_b64_tr_b16 v[136:137], v36 offset:64
  ds_read_b64_tr_b16 v[138:139], v36 offset:4288
  ds_read_b64_tr_b16 v[140:141], v36 offset:96
  ds_read_b64_tr_b16 v[142:143], v36 offset:4320
  ds_read_b64_tr_b16 v[144:145], v36 offset:128
  ds_read_b64_tr_b16 v[146:147], v36 offset:4352
  ds_read_b64_tr_b16 v[148:149], v36 offset:160
  ds_read_b64_tr_b16 v[150:151], v36 offset:4384
  ds_read_b64_tr_b16 v[152:153], v36 offset:192
  ds_read_b64_tr_b16 v[154:155], v36 offset:4416
  ds_read_b64_tr_b16 v[156:157], v36 offset:224
  ds_read_b64_tr_b16 v[158:159], v36 offset:4448
  s_waitcnt lgkmcnt(0)
L_w_ma_0:
  s_cbranch_execz L_w_ma_1
  s_barrier
  ds_read_b128 v[8:11], v166
  ds_read_b128 v[16:19], v6 offset:0
  ds_read_b128 v[20:23], v6 offset:64
  ds_read_b128 v[24:27], v6 offset:128
  ds_read_b128 v[28:31], v6 offset:192
L_w_ma_1:
  s_cbranch_execz L_w_ma_2
  ds_read_b128 v[32:35], v6 offset:256
  ds_read_b128 v[36:39], v6 offset:320
  ds_read_b128 v[40:43], v6 offset:384
  ds_read_b128 v[44:47], v6 offset:448
  ds_read_b128 v[48:51], v6 offset:512
  ds_read_b128 v[52:55], v6 offset:576
  ds_read_b128 v[56:59], v6 offset:640
L_w_ma_2:
  s_cbranch_execz L_w_ma_3
  ds_read_b128 v[60:63], v6 offset:704
  s_waitcnt lgkmcnt(11)
  v_mfma_f32_16x16x32_bf16 v[12:15], v[16:19], v[64:67], 0
  ds_read_b128 v[16:19], v6 offset:768
  v_add_f32 v8, v8, v10
  v_add_f32 v9, v9, v11
  s_waitcnt lgkmcnt(8)
  v_mfma_f32_16x16x32_bf16 v[12:15], v[20:23], v[68:71], v[12:15]
  ds_read_b128 v[20:23], v6 offset:832
  v_add_f32_dpp v8, v8, v8 quad_perm:[1,0,3,2] row_mask:0xf bank_mask:0xf
L_w_ma_3:
  s_cbranch_execz L_w_ma_4
  v_add_f32_dpp v9, v9, v9 quad_perm:[1,0,3,2] row_mask:0xf bank_mask:0xf
  v_mfma_f32_16x16x32_bf16 v[12:15], v[24:27], v[72:75], v[12:15]
  ds_read_b128 v[24:27], v6 offset:896
  v_add_f32_dpp v8, v8, v8 quad_perm:[2,3,0,1] row_mask:0xf bank_mask:0xf
  v_add_f32_dpp v9, v9, v9 quad_perm:[2,3,0,1] row_mask:0xf bank_mask:0xf
  v_mfma_f32_16x16x32_bf16 v[12:15], v[28:31], v[76:79], v[12:15]
  ds_read_b128 v[28:31], v6 offset:960
L_w_ma_4:
  s_cbranch_execz L_w_ma_5
  v_add_f32_dpp v8, v8, v8 row_half_mirror row_mask:0xf bank_mask:0xf
  v_add_f32_dpp v9, v9, v9 row_half_mirror row_mask:0xf bank_mask:0xf
  v_mfma_f32_16x16x32_bf16 v[12:15], v[32:35], v[80:83], v[12:15]
  v_add_f32_dpp v8, v8, v8 row_mirror row_mask:0xf bank_mask:0xf
  v_add_f32_dpp v9, v9, v9 row_mirror row_mask:0xf bank_mask:0xf
  s_waitcnt lgkmcnt(7)
  v_mfma_f32_16x16x32_bf16 v[12:15], v[36:39], v[84:87], v[12:15]
  v_mul_f32 v8, 0x3b000000, v8
L_w_ma_5:
  s_cbranch_execz L_w_ma_6
  v_mul_f32 v9, 0x3b000000, v9
  v_mfma_f32_16x16x32_bf16 v[12:15], v[40:43], v[88:91], v[12:15]
  v_fma_f32 v9, -v8, v8, v9
  v_add_f32 v8, v165, v8
  v_mfma_f32_16x16x32_bf16 v[12:15], v[44:47], v[92:95], v[12:15]
  v_max_f32 v9, 0, v9
  v_cvt_pk_bf16_f32 v10, v8, v9
  v_mfma_f32_16x16x32_bf16 v[12:15], v[48:51], v[96:99], v[12:15]
  v_lshlrev_b32 v8, 16, v10
L_w_ma_6:
  s_cbranch_execz L_w_ma_7
  v_and_b32 v9, 0xffff0000, v10
  s_waitcnt lgkmcnt(3)
  v_mfma_f32_16x16x32_bf16 v[12:15], v[52:55], v[100:103], v[12:15]
  v_add_f32 v9, 0x3727c5ac, v9
  v_cvt_pk_bf16_f32 v9, v9, v9
  v_mfma_f32_16x16x32_bf16 v[12:15], v[56:59], v[104:107], v[12:15]
  v_lshlrev_b32 v9, 16, v9
  v_sqrt_f32 v9, v9
  v_mfma_f32_16x16x32_bf16 v[12:15], v[60:63], v[108:111], v[12:15]
L_w_ma_7:
  s_cbranch_execz L_w_ma_8
  v_cvt_pk_bf16_f32 v9, v9, v9
  v_lshlrev_b32 v9, 16, v9
  v_mfma_f32_16x16x32_bf16 v[12:15], v[16:19], v[112:115], v[12:15]
  v_rcp_f32 v9, v9
  v_and_b32 v166, 31, v0
  s_waitcnt lgkmcnt(0)
  v_mfma_f32_16x16x32_bf16 v[12:15], v[20:23], v[116:119], v[12:15]
  v_lshlrev_b32 v166, 2, v166
  v_add_u32 v166, 106880, v166
  v_mfma_f32_16x16x32_bf16 v[12:15], v[24:27], v[120:123], v[12:15]
L_w_ma_8:
  s_cbranch_execz L_w_ma_9
  v_mfma_f32_16x16x32_bf16 v[12:15], v[28:31], v[124:127], v[12:15]
  s_nop 7
  v_fma_f32 v12, -v8, v167, v12
  v_mul_f32 v12, v12, v9
  v_mul_f32 v13, 0xbfb8aa3b, v12
  v_exp_f32 v13, v13
  v_mul_f32_dpp v14, v12, v12 row_ror:8 row_mask:0xf bank_mask:0xf
  v_add_f32 v13, 1.0, v13
  v_rcp_f32 v13, v13
  s_nop 0
  v_mul_f32 v13, v14, v13
L_w_ma_9:
  s_cbranch_execz L_w_ma_10
  s_nop 1
  v_mov_b32_dpp v14, v13 quad_perm:[1,0,3,2] row_mask:0xf bank_mask:0xf
  v_cvt_pk_bf16_f32 v13, v13, v14
  s_mov_b64 exec, 0x00550055
  ds_write_b32 v4, v13
  s_mov_b64 exec, -1
  s_mov_b32 s75, 1000000
L_pG:
  ds_read_b32 v32, v166
  ds_read_b128 v[16:19], v160
L_w_ma_10:
  s_cbranch_execz L_w_ma_11
  ds_read_b128 v[20:23], v161
  ds_read_b128 v[24:27], v162
  ds_read_b128 v[28:31], v163
  s_sub_u32 s75, s75, 1
  s_cbranch_scc1 L_pG_ok
  s_waitcnt lgkmcnt(4)
  v_cmp_eq_u32 vcc, -1, v32
  s_cbranch_vccnz L_pG
L_pG_ok:
  s_waitcnt lgkmcnt(3)
  v_mfma_f32_16x16x32_bf16 v[8:11], v[16:19], v[128:131], 0
L_w_ma_11:
  s_cbranch_execz L_w_ma_12
  v_mfma_f32_16x16x32_bf16 v[12:15], v[16:19], v[144:147], 0
  s_waitcnt lgkmcnt(2)
  v_mfma_f32_16x16x32_bf16 v[8:11], v[20:23], v[132:135], v[8:11]
  v_mfma_f32_16x16x32_bf16 v[12:15], v[20:23], v[148:151], v[12:15]
  s_waitcnt lgkmcnt(1)
  v_mfma_f32_16x16x32_bf16 v[8:11], v[24:27], v[136:139], v[8:11]
  v_mfma_f32_16x16x32_bf16 v[12:15], v[24:27], v[152:155], v[12:15]
  s_waitcnt lgkmcnt(0)
  v_mfma_f32_16x16x32_bf16 v[8:11], v[28:31], v[140:143], v[8:11]
L_w_ma_12:
  s_cbranch_execz L_wret
  v_mfma_f32_16x16x32_bf16 v[12:15], v[28:31], v[156:159], v[12:15]
  s_nop 6
  v_and_or_b32 v8, v8, s31, v7
  v_and_or_b32 v9, v9, s31, v164
  buffer_store_dwordx2 v[8:9], v5, s[24:27], s52 offen sc1
  v_and_or_b32 v12, v12, s31, v7
  v_and_or_b32 v13, v13, s31, v164
  buffer_store_dwordx2 v[12:13], v5, s[24:27], s53 offen sc1
L_fin:
L_end:
  s_endpgm
.section .rodata,"a"
.p2align 6
.amdhsa_kernel sequential_preLN__sliding_block_cached__moe_arch_mod__decode_kernel
  .amdhsa_next_free_vgpr 168
  .amdhsa_next_free_sgpr 102
  .amdhsa_accum_offset 168
  .amdhsa_group_segment_fixed_size 0
  .amdhsa_kernarg_size 104
  .amdhsa_user_sgpr_count 2
  .amdhsa_user_sgpr_kernarg_segment_ptr 1
  .amdhsa_system_sgpr_workgroup_id_x 1
.end_amdhsa_kernel
```
